```python
import torch

def _softmax(x, axis=-1):
    return torch.softmax(x, dim=axis)
def _gelu(x):
    return torch.nn.functional.gelu(x, approximate="tanh")
def _silu(x):
    return torch.nn.functional.silu(x)
def _sigmoid(x):
    return torch.sigmoid(x)
def _layernorm(x, axis=-1, eps=1e-5):
    m = x.mean(dim=axis, keepdim=True)
    v = x.var(dim=axis, keepdim=True, unbiased=False)
    return (x - m) / torch.sqrt(v + eps)
def _scatter_add(tgt, idx, src, axis=0):
    return tgt.clone().index_add_(axis, idx, src)
def _segment_sum(src, seg, n):
    out = torch.zeros((n,) + src.shape[1:], dtype=src.dtype)
    return out.index_add_(0, seg, src)
def _pad(x, pw):
    flat = tuple(v for pair in reversed(pw) for v in pair)
    return torch.nn.functional.pad(x, flat)

kernel_name = 'recurrent_scan__softmax_full_mha__dense_activation_relu__prompt'

def setup_inputs():

    _w = (lambda a: (lambda t: t.to(torch.bfloat16) if t.is_floating_point() else t)(torch.as_tensor(a)))
    def _A_setup():
        B, S, D = 1, 2048, 512
        return {
            "x": _w((lambda *s: torch.randn(*s, dtype=torch.bfloat16) * 0.05)(B, S, D)),
            "wqkv": _w((lambda *s: torch.randn(*s, dtype=torch.bfloat16) * 0.05)(D, 3 * D)),
            "wo": _w((lambda *s: torch.randn(*s, dtype=torch.bfloat16) * 0.05)(D, D)),
        }
    _A_in = _A_setup()

    def _B_setup():
        B, S, D, Dff = 1, 2048, 512, 1792
        return {
            "x": _w((lambda *s: torch.randn(*s, dtype=torch.bfloat16) * 0.05)(B, S, D)),
            "w1": _w((lambda *s: torch.randn(*s, dtype=torch.bfloat16) * 0.05)(D, Dff)),
            "w2": _w((lambda *s: torch.randn(*s, dtype=torch.bfloat16) * 0.05)(Dff, D)),
        }
    _B_in = _B_setup()

    return {
        "A_x": _A_in["x"],
        "A_wqkv": _A_in["wqkv"],
        "A_wo": _A_in["wo"],
        "B_x": _B_in["x"],
        "B_w1": _B_in["w1"],
        "B_w2": _B_in["w2"],
    }

def reference(A_x, A_wqkv, A_wo, B_x, B_w1, B_w2):
    def _A_ref(x, wqkv, wo):
        B, S, D = x.shape
        H = 32; Dh = D // H
        qkv = (lambda x, *d: x.permute(*d))((x @ wqkv).reshape(B, S, 3, H, Dh), 2, 0, 3, 1, 4)
        q, k, v = qkv[0], qkv[1], qkv[2]
        scale = Dh ** -0.5
        scores = torch.einsum("bhqd,bhkd->bhqk", q, k) * scale
        p = _softmax(scores, axis=-1)
        o = torch.einsum("bhqk,bhkd->bhqd", p, v)
        return (lambda x, *d: x.permute(*d))(o, 0, 2, 1, 3).reshape(B, S, D) @ wo

    def _B_ref(x, w1, w2):
        h = torch.einsum("bsd,df->bsf", x, w1)
        zero = torch.zeros_like(h)
        h = torch.maximum(h, zero)
        return torch.einsum("bsf,fd->bsd", h, w2)

    x = A_x
    xn = _layernorm(x, axis=-1)
    s = _A_ref(xn, A_wqkv, A_wo)
    g = _silu(_B_ref(xn, B_w1, B_w2))
    return x + s * g
```

```asm
; @launch grid=(256,1,1) block=(768,1,1) lds=151616
.amdgcn_target "amdgcn-amd-amdhsa--gfx950"
.text
.globl recurrent_scan__softmax_full_mha__dense_activation_relu__prompt_kernel
.p2align 8
.type recurrent_scan__softmax_full_mha__dense_activation_relu__prompt_kernel,@function
recurrent_scan__softmax_full_mha__dense_activation_relu__prompt_kernel:
  s_cmpk_ge_u32 s2, 0x100
  s_cbranch_scc1 L_done
  s_load_dwordx16 s[4:19], s[0:1], 0
  s_load_dwordx2 s[20:21], s[0:1], 64
  s_getpc_b64 s[98:99]
  s_andn2_b32 s58, s2, 7
  v_cmp_gt_u32 vcc, 8, v0
  v_add_lshl_u32 v12, s58, v0, 7
  v_mov_b32 v13, 0
  v_lshl_add_u64 v[12:13], v[12:13], 0, s[98:99]
  s_and_saveexec_b64 s[60:61], vcc
  s_cbranch_execz L_no_cpf
  global_load_dword v165, v[12:13], off
L_no_cpf:
  s_mov_b64 exec, -1
  v_lshrrev_b32 v2, 6, v0
  v_and_b32 v1, 63, v0
  s_and_b32 s56, s2, 7
  s_xor_b32 s56, s56, 1
  s_lshr_b32 s57, s2, 3
  v_readfirstlane_b32 s53, v2
  s_and_b32 s58, s56, 1
  s_lshl_b32 s58, s58, 4
  s_lshr_b32 s54, s57, 1
  s_add_u32 s54, s54, s58
  v_lshrrev_b32 v4, 3, v1
  v_and_b32 v5, 7, v1
  s_lshl_b32 s101, s54, 4
  s_add_u32 s101, s101, s53
  s_lshl_b32 s101, s101, 12
  v_lshrrev_b32 v10, 4, v1
  v_and_b32 v11, 15, v1
  v_lshlrev_b32 v9, 10, v10
  v_lshl_add_u32 v9, v11, 4, v9
  s_cmp_ge_u32 s53, 8
  s_cbranch_scc1 L_no_x
  s_mov_b32 s26, 0x200000
  s_mov_b32 s27, 0x20000
  s_waitcnt lgkmcnt(0)
  s_mov_b32 s24, s4
  s_and_b32 s25, s5, 0xffff
  buffer_load_dwordx4 v[16:19], v9, s[24:27], s101 offen offset:0
  buffer_load_dwordx4 v[20:23], v9, s[24:27], s101 offen offset:256
  buffer_load_dwordx4 v[24:27], v9, s[24:27], s101 offen offset:512
  buffer_load_dwordx4 v[28:31], v9, s[24:27], s101 offen offset:768
L_no_x:
  s_and_b32 s58, s56, 6
  s_and_b32 s55, s57, 1
  s_add_u32 s55, s55, s58
  s_mov_b32 s96, s55
  s_mov_b32 s97, s58
  s_and_b32 s59, s54, 7
  s_lshl_b32 s59, s59, 2
  s_lshr_b32 s59, 0x75317531, s59
  s_and_b32 s59, s59, 7
  s_cmp_gt_u32 s55, s59
  s_subb_u32 s96, s55, 0
  s_cmp_eq_u32 s55, s59
  s_cselect_b32 s96, 7, s96
  s_max_u32 s97, s97, 1
  s_sub_u32 s97, s97, 1
  s_mul_i32 s58, s53, 24576
  s_lshl_b32 s59, s55, 7
  s_add_u32 s58, s58, s59
  v_lshrrev_b32 v4, 3, v1
  v_and_b32 v5, 7, v1
  v_bfe_u32 v6, v1, 4, 1
  v_lshlrev_b32 v6, 2, v6
  v_xor_b32 v7, v5, v6
  v_lshlrev_b32 v8, 4, v7
  v_mul_u32_u24 v2, 3072, v4
  v_add3_u32 v2, v2, v8, s58
  s_and_b32 s3, s53, 3
  s_mul_i32 s3, s3, 3072
  s_add_u32 s3, s3, 65536
  v_mov_b32 v3, 151552
  s_mov_b32 s60, 25231360
  s_waitcnt lgkmcnt(0)
  s_load_dword s52, s[20:21], s60
  s_mov_b32 s24, s4
  s_and_b32 s25, s5, 0xffff
  s_mov_b32 s26, 0x200000
  s_mov_b32 s27, 0x20000
  s_mov_b32 s28, s6
  s_and_b32 s29, s7, 0xffff
  s_mov_b32 s30, 0x180000
  s_mov_b32 s31, 0x20000
  s_cmp_ge_u32 s53, 8
  s_cbranch_scc1 L_qkv
  s_add_u32 s101, s101, 32768
  buffer_load_dwordx4 v[32:35], v9, s[24:27], s101 offen offset:0
  buffer_load_dwordx4 v[36:39], v9, s[24:27], s101 offen offset:256
  buffer_load_dwordx4 v[40:43], v9, s[24:27], s101 offen offset:512
  buffer_load_dwordx4 v[44:47], v9, s[24:27], s101 offen offset:768
  s_mov_b32 s32, s8
  s_and_b32 s33, s9, 0xffff
  s_mov_b32 s34, 0x80000
  s_mov_b32 s35, 0x20000
  s_mov_b32 s36, s12
  s_and_b32 s37, s13, 0xffff
  s_mov_b32 s38, 0x1c0000
  s_mov_b32 s39, 0x20000
  s_mov_b32 s40, s14
  s_and_b32 s41, s15, 0xffff
  s_mov_b32 s42, 0x1c0000
  s_mov_b32 s43, 0x20000
  s_mov_b32 s44, s16
  s_and_b32 s45, s17, 0xffff
  s_mov_b32 s46, 0x200000
  s_mov_b32 s47, 0x20000
  s_mov_b32 s48, s20
  s_and_b32 s49, s21, 0xffff
  s_mov_b32 s50, 0x1940000
  s_mov_b32 s51, 0x20000
  s_lshl_b32 s58, s53, 2
  v_add_u32 v6, s58, v10
  v_and_b32 v7, 7, v11
  v_xor_b32 v6, v6, v7
  v_lshlrev_b32 v6, 4, v6
  v_lshrrev_b32 v7, 1, v11
  v_lshl_add_u32 v6, v7, 10, v6
  v_and_b32 v7, 1, v11
  v_lshl_add_u32 v10, v7, 9, v6
  s_mov_b32 s23, 0x3f803f80
  s_waitcnt vmcnt(7)
  v_dot2_f32_bf16 v12, v16, s23, 0
  v_dot2_f32_bf16 v14, v16, v16, 0
  v_dot2_f32_bf16 v13, v17, s23, 0
  v_dot2_f32_bf16 v15, v17, v17, 0
  v_dot2_f32_bf16 v12, v18, s23, v12
  v_dot2_f32_bf16 v14, v18, v18, v14
  v_dot2_f32_bf16 v13, v19, s23, v13
  v_dot2_f32_bf16 v15, v19, v19, v15
  s_waitcnt vmcnt(6)
  v_dot2_f32_bf16 v12, v20, s23, v12
  v_dot2_f32_bf16 v14, v20, v20, v14
  v_dot2_f32_bf16 v13, v21, s23, v13
  v_dot2_f32_bf16 v15, v21, v21, v15
  v_dot2_f32_bf16 v12, v22, s23, v12
  v_dot2_f32_bf16 v14, v22, v22, v14
  v_dot2_f32_bf16 v13, v23, s23, v13
  v_dot2_f32_bf16 v15, v23, v23, v15
  s_waitcnt vmcnt(5)
  v_dot2_f32_bf16 v12, v24, s23, v12
  v_dot2_f32_bf16 v14, v24, v24, v14
  v_dot2_f32_bf16 v13, v25, s23, v13
  v_dot2_f32_bf16 v15, v25, v25, v15
  v_dot2_f32_bf16 v12, v26, s23, v12
  v_dot2_f32_bf16 v14, v26, v26, v14
  v_dot2_f32_bf16 v13, v27, s23, v13
  v_dot2_f32_bf16 v15, v27, v27, v15
  s_waitcnt vmcnt(4)
  v_dot2_f32_bf16 v12, v28, s23, v12
  v_dot2_f32_bf16 v14, v28, v28, v14
  v_dot2_f32_bf16 v13, v29, s23, v13
  v_dot2_f32_bf16 v15, v29, v29, v15
  v_dot2_f32_bf16 v12, v30, s23, v12
  v_dot2_f32_bf16 v14, v30, v30, v14
  v_dot2_f32_bf16 v13, v31, s23, v13
  v_dot2_f32_bf16 v15, v31, v31, v15
  s_nop 1
  v_add_f32 v12, v12, v13
  v_add_f32 v14, v14, v15
  s_nop 0
  v_add_f32_dpp v12, v12, v12 quad_perm:[1,0,3,2] row_mask:0xf bank_mask:0xf
  v_add_f32_dpp v14, v14, v14 quad_perm:[1,0,3,2] row_mask:0xf bank_mask:0xf
  s_nop 0
  v_add_f32_dpp v12, v12, v12 quad_perm:[2,3,0,1] row_mask:0xf bank_mask:0xf
  v_add_f32_dpp v14, v14, v14 quad_perm:[2,3,0,1] row_mask:0xf bank_mask:0xf
  s_nop 0
  v_add_f32_dpp v12, v12, v12 row_half_mirror row_mask:0xf bank_mask:0xf
  v_add_f32_dpp v14, v14, v14 row_half_mirror row_mask:0xf bank_mask:0xf
  s_nop 0
  v_add_f32_dpp v12, v12, v12 row_mirror row_mask:0xf bank_mask:0xf
  v_add_f32_dpp v14, v14, v14 row_mirror row_mask:0xf bank_mask:0xf
  v_mul_f32 v12, 0x3b000000, v12
  v_mul_f32 v14, 0x3b000000, v14
  v_fma_f32 v14, -v12, v12, v14
  v_max_f32 v14, 0, v14
  v_cvt_pk_bf16_f32 v6, v12, v12
  v_lshlrev_b32 v12, 16, v6
  v_cvt_pk_bf16_f32 v7, v14, v14
  v_lshlrev_b32 v14, 16, v7
  v_add_f32 v14, 0x3727c5ac, v14
  v_cvt_pk_bf16_f32 v7, v14, v14
  v_lshlrev_b32 v14, 16, v7
  v_sqrt_f32 v14, v14
  s_nop 0
  v_cvt_pk_bf16_f32 v7, v14, v14
  v_lshlrev_b32 v14, 16, v7
  v_rcp_f32 v13, v14
  v_lshlrev_b32 v48, 16, v16
  v_and_b32 v49, 0xffff0000, v16
  v_lshlrev_b32 v50, 16, v17
  v_and_b32 v51, 0xffff0000, v17
  v_lshlrev_b32 v52, 16, v18
  v_and_b32 v53, 0xffff0000, v18
  v_lshlrev_b32 v54, 16, v19
  v_and_b32 v55, 0xffff0000, v19
  v_pk_add_f32 v[48:49], v[48:49], v[12:13] op_sel:[0,0] op_sel_hi:[1,0] neg_lo:[0,1] neg_hi:[0,1]
  v_pk_add_f32 v[50:51], v[50:51], v[12:13] op_sel:[0,0] op_sel_hi:[1,0] neg_lo:[0,1] neg_hi:[0,1]
  v_pk_add_f32 v[52:53], v[52:53], v[12:13] op_sel:[0,0] op_sel_hi:[1,0] neg_lo:[0,1] neg_hi:[0,1]
  v_pk_add_f32 v[54:55], v[54:55], v[12:13] op_sel:[0,0] op_sel_hi:[1,0] neg_lo:[0,1] neg_hi:[0,1]
  v_cvt_pk_bf16_f32 v16, v48, v49
  v_cvt_pk_bf16_f32 v17, v50, v51
  v_cvt_pk_bf16_f32 v18, v52, v53
  v_cvt_pk_bf16_f32 v19, v54, v55
  v_lshlrev_b32 v48, 16, v16
  v_and_b32 v49, 0xffff0000, v16
  v_lshlrev_b32 v50, 16, v17
  v_and_b32 v51, 0xffff0000, v17
  v_lshlrev_b32 v52, 16, v18
  v_and_b32 v53, 0xffff0000, v18
  v_lshlrev_b32 v54, 16, v19
  v_and_b32 v55, 0xffff0000, v19
  v_pk_mul_f32 v[48:49], v[48:49], v[12:13] op_sel:[0,1] op_sel_hi:[1,1]
  v_pk_mul_f32 v[50:51], v[50:51], v[12:13] op_sel:[0,1] op_sel_hi:[1,1]
  v_pk_mul_f32 v[52:53], v[52:53], v[12:13] op_sel:[0,1] op_sel_hi:[1,1]
  v_pk_mul_f32 v[54:55], v[54:55], v[12:13] op_sel:[0,1] op_sel_hi:[1,1]
  v_cvt_pk_bf16_f32 v16, v48, v49
  v_cvt_pk_bf16_f32 v17, v50, v51
  v_cvt_pk_bf16_f32 v18, v52, v53
  v_cvt_pk_bf16_f32 v19, v54, v55
  ds_write_b128 v10, v[16:19] offset:0
  v_lshlrev_b32 v48, 16, v20
  v_and_b32 v49, 0xffff0000, v20
  v_lshlrev_b32 v50, 16, v21
  v_and_b32 v51, 0xffff0000, v21
  v_lshlrev_b32 v52, 16, v22
  v_and_b32 v53, 0xffff0000, v22
  v_lshlrev_b32 v54, 16, v23
  v_and_b32 v55, 0xffff0000, v23
  v_pk_add_f32 v[48:49], v[48:49], v[12:13] op_sel:[0,0] op_sel_hi:[1,0] neg_lo:[0,1] neg_hi:[0,1]
  v_pk_add_f32 v[50:51], v[50:51], v[12:13] op_sel:[0,0] op_sel_hi:[1,0] neg_lo:[0,1] neg_hi:[0,1]
  v_pk_add_f32 v[52:53], v[52:53], v[12:13] op_sel:[0,0] op_sel_hi:[1,0] neg_lo:[0,1] neg_hi:[0,1]
  v_pk_add_f32 v[54:55], v[54:55], v[12:13] op_sel:[0,0] op_sel_hi:[1,0] neg_lo:[0,1] neg_hi:[0,1]
  v_cvt_pk_bf16_f32 v20, v48, v49
  v_cvt_pk_bf16_f32 v21, v50, v51
  v_cvt_pk_bf16_f32 v22, v52, v53
  v_cvt_pk_bf16_f32 v23, v54, v55
  v_lshlrev_b32 v48, 16, v20
  v_and_b32 v49, 0xffff0000, v20
  v_lshlrev_b32 v50, 16, v21
  v_and_b32 v51, 0xffff0000, v21
  v_lshlrev_b32 v52, 16, v22
  v_and_b32 v53, 0xffff0000, v22
  v_lshlrev_b32 v54, 16, v23
  v_and_b32 v55, 0xffff0000, v23
  v_pk_mul_f32 v[48:49], v[48:49], v[12:13] op_sel:[0,1] op_sel_hi:[1,1]
  v_pk_mul_f32 v[50:51], v[50:51], v[12:13] op_sel:[0,1] op_sel_hi:[1,1]
  v_pk_mul_f32 v[52:53], v[52:53], v[12:13] op_sel:[0,1] op_sel_hi:[1,1]
  v_pk_mul_f32 v[54:55], v[54:55], v[12:13] op_sel:[0,1] op_sel_hi:[1,1]
  v_cvt_pk_bf16_f32 v20, v48, v49
  v_cvt_pk_bf16_f32 v21, v50, v51
  v_cvt_pk_bf16_f32 v22, v52, v53
  v_cvt_pk_bf16_f32 v23, v54, v55
  ds_write_b128 v10, v[20:23] offset:8192
  v_lshlrev_b32 v48, 16, v24
  v_and_b32 v49, 0xffff0000, v24
  v_lshlrev_b32 v50, 16, v25
  v_and_b32 v51, 0xffff0000, v25
  v_lshlrev_b32 v52, 16, v26
  v_and_b32 v53, 0xffff0000, v26
  v_lshlrev_b32 v54, 16, v27
  v_and_b32 v55, 0xffff0000, v27
  v_pk_add_f32 v[48:49], v[48:49], v[12:13] op_sel:[0,0] op_sel_hi:[1,0] neg_lo:[0,1] neg_hi:[0,1]
  v_pk_add_f32 v[50:51], v[50:51], v[12:13] op_sel:[0,0] op_sel_hi:[1,0] neg_lo:[0,1] neg_hi:[0,1]
  v_pk_add_f32 v[52:53], v[52:53], v[12:13] op_sel:[0,0] op_sel_hi:[1,0] neg_lo:[0,1] neg_hi:[0,1]
  v_pk_add_f32 v[54:55], v[54:55], v[12:13] op_sel:[0,0] op_sel_hi:[1,0] neg_lo:[0,1] neg_hi:[0,1]
  v_cvt_pk_bf16_f32 v24, v48, v49
  v_cvt_pk_bf16_f32 v25, v50, v51
  v_cvt_pk_bf16_f32 v26, v52, v53
  v_cvt_pk_bf16_f32 v27, v54, v55
  v_lshlrev_b32 v48, 16, v24
  v_and_b32 v49, 0xffff0000, v24
  v_lshlrev_b32 v50, 16, v25
  v_and_b32 v51, 0xffff0000, v25
  v_lshlrev_b32 v52, 16, v26
  v_and_b32 v53, 0xffff0000, v26
  v_lshlrev_b32 v54, 16, v27
  v_and_b32 v55, 0xffff0000, v27
  v_pk_mul_f32 v[48:49], v[48:49], v[12:13] op_sel:[0,1] op_sel_hi:[1,1]
  v_pk_mul_f32 v[50:51], v[50:51], v[12:13] op_sel:[0,1] op_sel_hi:[1,1]
  v_pk_mul_f32 v[52:53], v[52:53], v[12:13] op_sel:[0,1] op_sel_hi:[1,1]
  v_pk_mul_f32 v[54:55], v[54:55], v[12:13] op_sel:[0,1] op_sel_hi:[1,1]
  v_cvt_pk_bf16_f32 v24, v48, v49
  v_cvt_pk_bf16_f32 v25, v50, v51
  v_cvt_pk_bf16_f32 v26, v52, v53
  v_cvt_pk_bf16_f32 v27, v54, v55
  ds_write_b128 v10, v[24:27] offset:16384
  v_lshlrev_b32 v48, 16, v28
  v_and_b32 v49, 0xffff0000, v28
  v_lshlrev_b32 v50, 16, v29
  v_and_b32 v51, 0xffff0000, v29
  v_lshlrev_b32 v52, 16, v30
  v_and_b32 v53, 0xffff0000, v30
  v_lshlrev_b32 v54, 16, v31
  v_and_b32 v55, 0xffff0000, v31
  v_pk_add_f32 v[48:49], v[48:49], v[12:13] op_sel:[0,0] op_sel_hi:[1,0] neg_lo:[0,1] neg_hi:[0,1]
  v_pk_add_f32 v[50:51], v[50:51], v[12:13] op_sel:[0,0] op_sel_hi:[1,0] neg_lo:[0,1] neg_hi:[0,1]
  v_pk_add_f32 v[52:53], v[52:53], v[12:13] op_sel:[0,0] op_sel_hi:[1,0] neg_lo:[0,1] neg_hi:[0,1]
  v_pk_add_f32 v[54:55], v[54:55], v[12:13] op_sel:[0,0] op_sel_hi:[1,0] neg_lo:[0,1] neg_hi:[0,1]
  v_cvt_pk_bf16_f32 v28, v48, v49
  v_cvt_pk_bf16_f32 v29, v50, v51
  v_cvt_pk_bf16_f32 v30, v52, v53
  v_cvt_pk_bf16_f32 v31, v54, v55
  v_lshlrev_b32 v48, 16, v28
  v_and_b32 v49, 0xffff0000, v28
  v_lshlrev_b32 v50, 16, v29
  v_and_b32 v51, 0xffff0000, v29
  v_lshlrev_b32 v52, 16, v30
  v_and_b32 v53, 0xffff0000, v30
  v_lshlrev_b32 v54, 16, v31
  v_and_b32 v55, 0xffff0000, v31
  v_pk_mul_f32 v[48:49], v[48:49], v[12:13] op_sel:[0,1] op_sel_hi:[1,1]
  v_pk_mul_f32 v[50:51], v[50:51], v[12:13] op_sel:[0,1] op_sel_hi:[1,1]
  v_pk_mul_f32 v[52:53], v[52:53], v[12:13] op_sel:[0,1] op_sel_hi:[1,1]
  v_pk_mul_f32 v[54:55], v[54:55], v[12:13] op_sel:[0,1] op_sel_hi:[1,1]
  v_cvt_pk_bf16_f32 v28, v48, v49
  v_cvt_pk_bf16_f32 v29, v50, v51
  v_cvt_pk_bf16_f32 v30, v52, v53
  v_cvt_pk_bf16_f32 v31, v54, v55
  ds_write_b128 v10, v[28:31] offset:24576
  s_waitcnt vmcnt(3)
  v_dot2_f32_bf16 v12, v32, s23, 0
  v_dot2_f32_bf16 v14, v32, v32, 0
  v_dot2_f32_bf16 v13, v33, s23, 0
  v_dot2_f32_bf16 v15, v33, v33, 0
  v_dot2_f32_bf16 v12, v34, s23, v12
  v_dot2_f32_bf16 v14, v34, v34, v14
  v_dot2_f32_bf16 v13, v35, s23, v13
  v_dot2_f32_bf16 v15, v35, v35, v15
  s_waitcnt vmcnt(2)
  v_dot2_f32_bf16 v12, v36, s23, v12
  v_dot2_f32_bf16 v14, v36, v36, v14
  v_dot2_f32_bf16 v13, v37, s23, v13
  v_dot2_f32_bf16 v15, v37, v37, v15
  v_dot2_f32_bf16 v12, v38, s23, v12
  v_dot2_f32_bf16 v14, v38, v38, v14
  v_dot2_f32_bf16 v13, v39, s23, v13
  v_dot2_f32_bf16 v15, v39, v39, v15
  s_waitcnt vmcnt(1)
  v_dot2_f32_bf16 v12, v40, s23, v12
  v_dot2_f32_bf16 v14, v40, v40, v14
  v_dot2_f32_bf16 v13, v41, s23, v13
  v_dot2_f32_bf16 v15, v41, v41, v15
  v_dot2_f32_bf16 v12, v42, s23, v12
  v_dot2_f32_bf16 v14, v42, v42, v14
  v_dot2_f32_bf16 v13, v43, s23, v13
  v_dot2_f32_bf16 v15, v43, v43, v15
  s_waitcnt vmcnt(0)
  v_dot2_f32_bf16 v12, v44, s23, v12
  v_dot2_f32_bf16 v14, v44, v44, v14
  v_dot2_f32_bf16 v13, v45, s23, v13
  v_dot2_f32_bf16 v15, v45, v45, v15
  v_dot2_f32_bf16 v12, v46, s23, v12
  v_dot2_f32_bf16 v14, v46, v46, v14
  v_dot2_f32_bf16 v13, v47, s23, v13
  v_dot2_f32_bf16 v15, v47, v47, v15
  s_nop 1
  v_add_f32 v12, v12, v13
  v_add_f32 v14, v14, v15
  s_nop 0
  v_add_f32_dpp v12, v12, v12 quad_perm:[1,0,3,2] row_mask:0xf bank_mask:0xf
  v_add_f32_dpp v14, v14, v14 quad_perm:[1,0,3,2] row_mask:0xf bank_mask:0xf
  s_nop 0
  v_add_f32_dpp v12, v12, v12 quad_perm:[2,3,0,1] row_mask:0xf bank_mask:0xf
  v_add_f32_dpp v14, v14, v14 quad_perm:[2,3,0,1] row_mask:0xf bank_mask:0xf
  s_nop 0
  v_add_f32_dpp v12, v12, v12 row_half_mirror row_mask:0xf bank_mask:0xf
  v_add_f32_dpp v14, v14, v14 row_half_mirror row_mask:0xf bank_mask:0xf
  s_nop 0
  v_add_f32_dpp v12, v12, v12 row_mirror row_mask:0xf bank_mask:0xf
  v_add_f32_dpp v14, v14, v14 row_mirror row_mask:0xf bank_mask:0xf
  v_mul_f32 v12, 0x3b000000, v12
  v_mul_f32 v14, 0x3b000000, v14
  v_fma_f32 v14, -v12, v12, v14
  v_max_f32 v14, 0, v14
  v_cvt_pk_bf16_f32 v6, v12, v12
  v_lshlrev_b32 v12, 16, v6
  v_cvt_pk_bf16_f32 v7, v14, v14
  v_lshlrev_b32 v14, 16, v7
  v_add_f32 v14, 0x3727c5ac, v14
  v_cvt_pk_bf16_f32 v7, v14, v14
  v_lshlrev_b32 v14, 16, v7
  v_sqrt_f32 v14, v14
  s_nop 0
  v_cvt_pk_bf16_f32 v7, v14, v14
  v_lshlrev_b32 v14, 16, v7
  v_rcp_f32 v13, v14
  v_lshlrev_b32 v48, 16, v32
  v_and_b32 v49, 0xffff0000, v32
  v_lshlrev_b32 v50, 16, v33
  v_and_b32 v51, 0xffff0000, v33
  v_lshlrev_b32 v52, 16, v34
  v_and_b32 v53, 0xffff0000, v34
  v_lshlrev_b32 v54, 16, v35
  v_and_b32 v55, 0xffff0000, v35
  v_pk_add_f32 v[48:49], v[48:49], v[12:13] op_sel:[0,0] op_sel_hi:[1,0] neg_lo:[0,1] neg_hi:[0,1]
  v_pk_add_f32 v[50:51], v[50:51], v[12:13] op_sel:[0,0] op_sel_hi:[1,0] neg_lo:[0,1] neg_hi:[0,1]
  v_pk_add_f32 v[52:53], v[52:53], v[12:13] op_sel:[0,0] op_sel_hi:[1,0] neg_lo:[0,1] neg_hi:[0,1]
  v_pk_add_f32 v[54:55], v[54:55], v[12:13] op_sel:[0,0] op_sel_hi:[1,0] neg_lo:[0,1] neg_hi:[0,1]
  v_cvt_pk_bf16_f32 v32, v48, v49
  v_cvt_pk_bf16_f32 v33, v50, v51
  v_cvt_pk_bf16_f32 v34, v52, v53
  v_cvt_pk_bf16_f32 v35, v54, v55
  v_lshlrev_b32 v48, 16, v32
  v_and_b32 v49, 0xffff0000, v32
  v_lshlrev_b32 v50, 16, v33
  v_and_b32 v51, 0xffff0000, v33
  v_lshlrev_b32 v52, 16, v34
  v_and_b32 v53, 0xffff0000, v34
  v_lshlrev_b32 v54, 16, v35
  v_and_b32 v55, 0xffff0000, v35
  v_pk_mul_f32 v[48:49], v[48:49], v[12:13] op_sel:[0,1] op_sel_hi:[1,1]
  v_pk_mul_f32 v[50:51], v[50:51], v[12:13] op_sel:[0,1] op_sel_hi:[1,1]
  v_pk_mul_f32 v[52:53], v[52:53], v[12:13] op_sel:[0,1] op_sel_hi:[1,1]
  v_pk_mul_f32 v[54:55], v[54:55], v[12:13] op_sel:[0,1] op_sel_hi:[1,1]
  v_cvt_pk_bf16_f32 v32, v48, v49
  v_cvt_pk_bf16_f32 v33, v50, v51
  v_cvt_pk_bf16_f32 v34, v52, v53
  v_cvt_pk_bf16_f32 v35, v54, v55
  ds_write_b128 v10, v[32:35] offset:32768
  v_lshlrev_b32 v48, 16, v36
  v_and_b32 v49, 0xffff0000, v36
  v_lshlrev_b32 v50, 16, v37
  v_and_b32 v51, 0xffff0000, v37
  v_lshlrev_b32 v52, 16, v38
  v_and_b32 v53, 0xffff0000, v38
  v_lshlrev_b32 v54, 16, v39
  v_and_b32 v55, 0xffff0000, v39
  v_pk_add_f32 v[48:49], v[48:49], v[12:13] op_sel:[0,0] op_sel_hi:[1,0] neg_lo:[0,1] neg_hi:[0,1]
  v_pk_add_f32 v[50:51], v[50:51], v[12:13] op_sel:[0,0] op_sel_hi:[1,0] neg_lo:[0,1] neg_hi:[0,1]
  v_pk_add_f32 v[52:53], v[52:53], v[12:13] op_sel:[0,0] op_sel_hi:[1,0] neg_lo:[0,1] neg_hi:[0,1]
  v_pk_add_f32 v[54:55], v[54:55], v[12:13] op_sel:[0,0] op_sel_hi:[1,0] neg_lo:[0,1] neg_hi:[0,1]
  v_cvt_pk_bf16_f32 v36, v48, v49
  v_cvt_pk_bf16_f32 v37, v50, v51
  v_cvt_pk_bf16_f32 v38, v52, v53
  v_cvt_pk_bf16_f32 v39, v54, v55
  v_lshlrev_b32 v48, 16, v36
  v_and_b32 v49, 0xffff0000, v36
  v_lshlrev_b32 v50, 16, v37
  v_and_b32 v51, 0xffff0000, v37
  v_lshlrev_b32 v52, 16, v38
  v_and_b32 v53, 0xffff0000, v38
  v_lshlrev_b32 v54, 16, v39
  v_and_b32 v55, 0xffff0000, v39
  v_pk_mul_f32 v[48:49], v[48:49], v[12:13] op_sel:[0,1] op_sel_hi:[1,1]
  v_pk_mul_f32 v[50:51], v[50:51], v[12:13] op_sel:[0,1] op_sel_hi:[1,1]
  v_pk_mul_f32 v[52:53], v[52:53], v[12:13] op_sel:[0,1] op_sel_hi:[1,1]
  v_pk_mul_f32 v[54:55], v[54:55], v[12:13] op_sel:[0,1] op_sel_hi:[1,1]
  v_cvt_pk_bf16_f32 v36, v48, v49
  v_cvt_pk_bf16_f32 v37, v50, v51
  v_cvt_pk_bf16_f32 v38, v52, v53
  v_cvt_pk_bf16_f32 v39, v54, v55
  ds_write_b128 v10, v[36:39] offset:40960
  v_lshlrev_b32 v48, 16, v40
  v_and_b32 v49, 0xffff0000, v40
  v_lshlrev_b32 v50, 16, v41
  v_and_b32 v51, 0xffff0000, v41
  v_lshlrev_b32 v52, 16, v42
  v_and_b32 v53, 0xffff0000, v42
  v_lshlrev_b32 v54, 16, v43
  v_and_b32 v55, 0xffff0000, v43
  v_pk_add_f32 v[48:49], v[48:49], v[12:13] op_sel:[0,0] op_sel_hi:[1,0] neg_lo:[0,1] neg_hi:[0,1]
  v_pk_add_f32 v[50:51], v[50:51], v[12:13] op_sel:[0,0] op_sel_hi:[1,0] neg_lo:[0,1] neg_hi:[0,1]
  v_pk_add_f32 v[52:53], v[52:53], v[12:13] op_sel:[0,0] op_sel_hi:[1,0] neg_lo:[0,1] neg_hi:[0,1]
  v_pk_add_f32 v[54:55], v[54:55], v[12:13] op_sel:[0,0] op_sel_hi:[1,0] neg_lo:[0,1] neg_hi:[0,1]
  v_cvt_pk_bf16_f32 v40, v48, v49
  v_cvt_pk_bf16_f32 v41, v50, v51
  v_cvt_pk_bf16_f32 v42, v52, v53
  v_cvt_pk_bf16_f32 v43, v54, v55
  v_lshlrev_b32 v48, 16, v40
  v_and_b32 v49, 0xffff0000, v40
  v_lshlrev_b32 v50, 16, v41
  v_and_b32 v51, 0xffff0000, v41
  v_lshlrev_b32 v52, 16, v42
  v_and_b32 v53, 0xffff0000, v42
  v_lshlrev_b32 v54, 16, v43
  v_and_b32 v55, 0xffff0000, v43
  v_pk_mul_f32 v[48:49], v[48:49], v[12:13] op_sel:[0,1] op_sel_hi:[1,1]
  v_pk_mul_f32 v[50:51], v[50:51], v[12:13] op_sel:[0,1] op_sel_hi:[1,1]
  v_pk_mul_f32 v[52:53], v[52:53], v[12:13] op_sel:[0,1] op_sel_hi:[1,1]
  v_pk_mul_f32 v[54:55], v[54:55], v[12:13] op_sel:[0,1] op_sel_hi:[1,1]
  v_cvt_pk_bf16_f32 v40, v48, v49
  v_cvt_pk_bf16_f32 v41, v50, v51
  v_cvt_pk_bf16_f32 v42, v52, v53
  v_cvt_pk_bf16_f32 v43, v54, v55
  ds_write_b128 v10, v[40:43] offset:49152
  v_lshlrev_b32 v48, 16, v44
  v_and_b32 v49, 0xffff0000, v44
  v_lshlrev_b32 v50, 16, v45
  v_and_b32 v51, 0xffff0000, v45
  v_lshlrev_b32 v52, 16, v46
  v_and_b32 v53, 0xffff0000, v46
  v_lshlrev_b32 v54, 16, v47
  v_and_b32 v55, 0xffff0000, v47
  v_pk_add_f32 v[48:49], v[48:49], v[12:13] op_sel:[0,0] op_sel_hi:[1,0] neg_lo:[0,1] neg_hi:[0,1]
  v_pk_add_f32 v[50:51], v[50:51], v[12:13] op_sel:[0,0] op_sel_hi:[1,0] neg_lo:[0,1] neg_hi:[0,1]
  v_pk_add_f32 v[52:53], v[52:53], v[12:13] op_sel:[0,0] op_sel_hi:[1,0] neg_lo:[0,1] neg_hi:[0,1]
  v_pk_add_f32 v[54:55], v[54:55], v[12:13] op_sel:[0,0] op_sel_hi:[1,0] neg_lo:[0,1] neg_hi:[0,1]
  v_cvt_pk_bf16_f32 v44, v48, v49
  v_cvt_pk_bf16_f32 v45, v50, v51
  v_cvt_pk_bf16_f32 v46, v52, v53
  v_cvt_pk_bf16_f32 v47, v54, v55
  v_lshlrev_b32 v48, 16, v44
  v_and_b32 v49, 0xffff0000, v44
  v_lshlrev_b32 v50, 16, v45
  v_and_b32 v51, 0xffff0000, v45
  v_lshlrev_b32 v52, 16, v46
  v_and_b32 v53, 0xffff0000, v46
  v_lshlrev_b32 v54, 16, v47
  v_and_b32 v55, 0xffff0000, v47
  v_pk_mul_f32 v[48:49], v[48:49], v[12:13] op_sel:[0,1] op_sel_hi:[1,1]
  v_pk_mul_f32 v[50:51], v[50:51], v[12:13] op_sel:[0,1] op_sel_hi:[1,1]
  v_pk_mul_f32 v[52:53], v[52:53], v[12:13] op_sel:[0,1] op_sel_hi:[1,1]
  v_pk_mul_f32 v[54:55], v[54:55], v[12:13] op_sel:[0,1] op_sel_hi:[1,1]
  v_cvt_pk_bf16_f32 v44, v48, v49
  v_cvt_pk_bf16_f32 v45, v50, v51
  v_cvt_pk_bf16_f32 v46, v52, v53
  v_cvt_pk_bf16_f32 v47, v54, v55
  ds_write_b128 v10, v[44:47] offset:57344
  s_waitcnt lgkmcnt(0)
  s_mul_i32 s52, s52, 0x9E3779B1
  s_add_u32 s52, s52, 0x7F4A7C15
  s_cmp_ge_u32 s53, 4
  s_cbranch_scc1 L_ln_odd
  s_waitcnt lgkmcnt(0)
  s_barrier
  s_barrier
  s_add_u32 m0, s3, 12288
  s_mov_b32 s22, 786432
  buffer_load_dwordx4 v2, s[28:31], s22 offen offset:0 lds
  buffer_load_dwordx4 v2, s[28:31], s22 offen offset:1024 lds
  buffer_load_dwordx4 v2, s[28:31], s22 offen offset:2048 lds
  s_barrier
  s_add_u32 m0, s3, 36864
  s_mov_b32 s22, 983040
  buffer_load_dwordx4 v2, s[28:31], s22 offen offset:0 lds
  buffer_load_dwordx4 v2, s[28:31], s22 offen offset:1024 lds
  buffer_load_dwordx4 v2, s[28:31], s22 offen offset:2048 lds
  s_barrier
  s_add_u32 m0, s3, 61440
  s_mov_b32 s22, 1179648
  buffer_load_dwordx4 v2, s[28:31], s22 offen offset:0 lds
  buffer_load_dwordx4 v2, s[28:31], s22 offen offset:1024 lds
  buffer_load_dwordx4 v2, s[28:31], s22 offen offset:2048 lds
  s_waitcnt vmcnt(6)
  s_barrier
  s_add_u32 m0, s3, 0
  s_mov_b32 s22, 1376256
  buffer_load_dwordx4 v2, s[28:31], s22 offen offset:0 lds
  buffer_load_dwordx4 v2, s[28:31], s22 offen offset:1024 lds
  buffer_load_dwordx4 v2, s[28:31], s22 offen offset:2048 lds
  s_waitcnt vmcnt(6)
  s_barrier
  s_lshl_b32 s60, s57, 3
  s_add_u32 s60, s60, s53
  s_mul_i32 s61, s60, 7168
  s_lshl_b32 s63, s97, 9
  s_add_u32 s61, s61, s63
  v_and_b32 v11, 31, v1
  v_lshlrev_b32 v11, 7, v11
  v_lshrrev_b32 v6, 5, v1
  v_mul_u32_u24 v7, 3584, v6
  v_add_u32 v7, v11, v7
  s_mov_b32 exec_lo, 0xfff
  s_mov_b32 exec_hi, 0xfff
  buffer_load_dword v61, v7, s[36:39], s61 offen
  s_mov_b64 exec, -1
  s_waitcnt vmcnt(4)
  s_barrier
  s_waitcnt vmcnt(1)
  s_barrier
  s_waitcnt vmcnt(0)
  s_branch L_att
L_ln_odd:
  s_waitcnt lgkmcnt(0)
  s_barrier
  s_barrier
  s_add_u32 m0, s3, 0
  s_mov_b32 s22, 589824
  buffer_load_dwordx4 v2, s[28:31], s22 offen offset:0 lds
  buffer_load_dwordx4 v2, s[28:31], s22 offen offset:1024 lds
  buffer_load_dwordx4 v2, s[28:31], s22 offen offset:2048 lds
  s_barrier
  s_add_u32 m0, s3, 24576
  s_mov_b32 s22, 786432
  buffer_load_dwordx4 v2, s[28:31], s22 offen offset:0 lds
  buffer_load_dwordx4 v2, s[28:31], s22 offen offset:1024 lds
  buffer_load_dwordx4 v2, s[28:31], s22 offen offset:2048 lds
  s_waitcnt vmcnt(3)
  s_barrier
  s_add_u32 m0, s3, 49152
  s_mov_b32 s22, 983040
  buffer_load_dwordx4 v2, s[28:31], s22 offen offset:0 lds
  buffer_load_dwordx4 v2, s[28:31], s22 offen offset:1024 lds
  buffer_load_dwordx4 v2, s[28:31], s22 offen offset:2048 lds
  s_waitcnt vmcnt(3)
  s_barrier
  s_add_u32 m0, s3, 73728
  s_mov_b32 s22, 1179648
  buffer_load_dwordx4 v2, s[28:31], s22 offen offset:0 lds
  buffer_load_dwordx4 v2, s[28:31], s22 offen offset:1024 lds
  buffer_load_dwordx4 v2, s[28:31], s22 offen offset:2048 lds
  s_waitcnt vmcnt(3)
  s_barrier
  s_add_u32 m0, s3, 12288
  s_mov_b32 s22, 1376256
  buffer_load_dwordx4 v2, s[28:31], s22 offen offset:0 lds
  buffer_load_dwordx4 v2, s[28:31], s22 offen offset:1024 lds
  buffer_load_dwordx4 v2, s[28:31], s22 offen offset:2048 lds
  s_lshl_b32 s60, s57, 3
  s_add_u32 s60, s60, s53
  s_mul_i32 s61, s60, 7168
  s_lshl_b32 s63, s97, 9
  s_add_u32 s61, s61, s63
  v_and_b32 v11, 31, v1
  v_lshlrev_b32 v11, 7, v11
  v_lshrrev_b32 v6, 5, v1
  v_mul_u32_u24 v7, 3584, v6
  v_add_u32 v7, v11, v7
  s_mov_b32 exec_lo, 0xfff
  s_mov_b32 exec_hi, 0xfff
  buffer_load_dword v61, v7, s[36:39], s61 offen
  s_mov_b64 exec, -1
  s_waitcnt vmcnt(4)
  s_barrier
  s_waitcnt vmcnt(1)
  s_barrier
  s_waitcnt vmcnt(0)
  s_branch L_att
L_qkv:
  s_lshl_b32 s58, s57, 2
  s_add_u32 s58, s58, s53
  s_sub_u32 s58, s58, 8
  s_mul_i32 s58, s58, 12288
  s_and_b32 s59, s56, 6
  s_lshl_b32 s59, s59, 7
  s_add_u32 s58, s58, s59
  v_and_b32 v20, 1, v1
  v_lshlrev_b32 v20, 7, v20
  v_bfe_u32 v21, v1, 1, 2
  v_lshl_add_u32 v20, v21, 10, v20
  v_lshrrev_b32 v21, 3, v1
  v_mul_u32_u24 v21, 3072, v21
  v_add_u32 v20, v20, v21
  s_mov_b32 exec_lo, 0x3f3f3f3f
  s_mov_b32 exec_hi, 0x0
  buffer_load_dword v164, v20, s[28:31], s58 offen
  s_mov_b64 exec, -1
  s_mov_b32 s32, s8
  s_and_b32 s33, s9, 0xffff
  s_mov_b32 s34, 0x80000
  s_mov_b32 s35, 0x20000
  s_mov_b32 s36, s12
  s_and_b32 s37, s13, 0xffff
  s_mov_b32 s38, 0x1c0000
  s_mov_b32 s39, 0x20000
  s_mov_b32 s40, s14
  s_and_b32 s41, s15, 0xffff
  s_mov_b32 s42, 0x1c0000
  s_mov_b32 s43, 0x20000
  s_mov_b32 s44, s16
  s_and_b32 s45, s17, 0xffff
  s_mov_b32 s46, 0x200000
  s_mov_b32 s47, 0x20000
  s_mov_b32 s48, s20
  s_and_b32 s49, s21, 0xffff
  s_mov_b32 s50, 0x1940000
  s_mov_b32 s51, 0x20000
  v_mov_b32 v12, 0
  v_mov_b32 v13, 0
  v_mov_b32 v14, 0
  v_mov_b32 v15, 0
  ds_write_b128 v3, v[12:15]
  ds_write_b128 v3, v[12:15] offset:16
  ds_write_b128 v3, v[12:15] offset:32
  ds_write_b128 v3, v[12:15] offset:48
  s_bfe_u32 s4, s53, 0x10001
  s_and_b32 s5, s53, 1
  v_and_b32 v9, 31, v1
  v_lshrrev_b32 v10, 5, v1
  s_lshl_b32 s58, s4, 15
  v_lshl_add_u32 v6, v10, 9, s58
  v_xor_b32 v7, 0, v10
  v_xor_b32 v7, v7, v9
  v_lshl_add_u32 v12, v7, 4, v6
  v_xor_b32 v7, 2, v10
  v_xor_b32 v7, v7, v9
  v_lshl_add_u32 v13, v7, 4, v6
  v_xor_b32 v7, 4, v10
  v_xor_b32 v7, v7, v9
  v_lshl_add_u32 v14, v7, 4, v6
  v_xor_b32 v7, 6, v10
  v_xor_b32 v7, v7, v9
  v_lshl_add_u32 v15, v7, 4, v6
  v_and_b32 v5, 15, v1
  v_lshrrev_b32 v6, 2, v5
  v_lshlrev_b32 v6, 7, v6
  v_lshrrev_b32 v7, 3, v5
  v_xor_b32 v7, s5, v7
  v_lshl_add_u32 v6, v7, 6, v6
  v_and_b32 v7, 3, v5
  v_lshl_add_u32 v6, v7, 3, v6
  v_bfe_u32 v7, v1, 4, 1
  v_lshl_add_u32 v6, v7, 5, v6
  v_mul_u32_u24 v7, 3072, v10
  v_add_u32 v6, v6, v7
  v_add_u32 v16, 65536, v6
  v_add_u32 v17, 77824, v6
  v_add_u32 v19, 90112, v6
  s_mov_b32 s13, 12288
  s_mov_b32 s14, 24576
  s_mov_b32 s15, 7
  v_mov_b32 v88, 0
  v_mov_b32 v89, 0
  v_mov_b32 v90, 0
  v_mov_b32 v91, 0
  v_mov_b32 v92, 0
  v_mov_b32 v93, 0
  v_mov_b32 v94, 0
  v_mov_b32 v95, 0
  v_mov_b32 v96, 0
  v_mov_b32 v97, 0
  v_mov_b32 v98, 0
  v_mov_b32 v99, 0
  v_mov_b32 v100, 0
  v_mov_b32 v101, 0
  v_mov_b32 v102, 0
  v_mov_b32 v103, 0
  v_mov_b32 v104, 0
  v_mov_b32 v105, 0
  v_mov_b32 v106, 0
  v_mov_b32 v107, 0
  v_mov_b32 v108, 0
  v_mov_b32 v109, 0
  v_mov_b32 v110, 0
  v_mov_b32 v111, 0
  v_mov_b32 v112, 0
  v_mov_b32 v113, 0
  v_mov_b32 v114, 0
  v_mov_b32 v115, 0
  v_mov_b32 v116, 0
  v_mov_b32 v117, 0
  v_mov_b32 v118, 0
  v_mov_b32 v119, 0
  v_mov_b32 v120, 0
  v_mov_b32 v121, 0
  v_mov_b32 v122, 0
  v_mov_b32 v123, 0
  v_mov_b32 v124, 0
  v_mov_b32 v125, 0
  v_mov_b32 v126, 0
  v_mov_b32 v127, 0
  v_mov_b32 v128, 0
  v_mov_b32 v129, 0
  v_mov_b32 v130, 0
  v_mov_b32 v131, 0
  v_mov_b32 v132, 0
  v_mov_b32 v133, 0
  v_mov_b32 v134, 0
  v_mov_b32 v135, 0
  s_lshl_b32 s6, s54, 1
  s_add_u32 s6, s6, s4
  s_lshl_b32 s7, s55, 2
  s_lshl_b32 s58, s5, 1
  s_add_u32 s7, s7, s58
  s_lshl_b32 s8, s7, 16
  s_lshl_b32 s58, s6, 10
  s_add_u32 s8, s8, s58
  s_add_u32 s9, s8, 65536
  s_lshl_b32 s10, s8, 1
  s_add_u32 s10, s10, 2097152
  s_add_u32 s11, s10, 131072
  v_lshlrev_b32 v11, 4, v1
  v_bfe_u32 v4, v1, 4, 1
  v_lshlrev_b32 v4, 17, v4
  v_and_b32 v5, 15, v1
  v_lshl_add_u32 v4, v5, 4, v4
  v_lshl_add_u32 v18, v10, 8, v4
  s_mov_b32 s12, 0x3eb8aa3b
  s_lshl_b32 s58, s55, 12
  s_lshl_b32 s59, s54, 7
  s_add_u32 s58, s58, s59
  s_add_u32 s23, s58, 25165824
  v_subrev_u32 v2, 196608, v2
  s_waitcnt vmcnt(0)
  s_add_u32 m0, s3, 0
  s_mov_b32 s22, 0
  buffer_load_dwordx4 v2, s[28:31], s22 offen offset:0 lds
  buffer_load_dwordx4 v2, s[28:31], s22 offen offset:1024 lds
  buffer_load_dwordx4 v2, s[28:31], s22 offen offset:2048 lds
  s_add_u32 m0, s3, 12288
  s_mov_b32 s22, 98304
  buffer_load_dwordx4 v2, s[28:31], s22 offen offset:0 lds
  buffer_load_dwordx4 v2, s[28:31], s22 offen offset:1024 lds
  buffer_load_dwordx4 v2, s[28:31], s22 offen offset:2048 lds
  s_waitcnt vmcnt(5)
  s_add_u32 m0, s3, 24576
  s_mov_b32 s22, 196608
  buffer_load_dwordx4 v2, s[28:31], s22 offen offset:0 lds
  buffer_load_dwordx4 v2, s[28:31], s22 offen offset:1024 lds
  buffer_load_dwordx4 v2, s[28:31], s22 offen offset:2048 lds
  s_add_u32 m0, s3, 36864
  s_mov_b32 s22, 294912
  buffer_load_dwordx4 v2, s[28:31], s22 offen offset:0 lds
  buffer_load_dwordx4 v2, s[28:31], s22 offen offset:1024 lds
  buffer_load_dwordx4 v2, s[28:31], s22 offen offset:2048 lds
  s_waitcnt vmcnt(6)
  s_add_u32 m0, s3, 49152
  s_mov_b32 s22, 393216
  buffer_load_dwordx4 v2, s[28:31], s22 offen offset:0 lds
  buffer_load_dwordx4 v2, s[28:31], s22 offen offset:1024 lds
  buffer_load_dwordx4 v2, s[28:31], s22 offen offset:2048 lds
  s_add_u32 m0, s3, 61440
  s_mov_b32 s22, 491520
  buffer_load_dwordx4 v2, s[28:31], s22 offen offset:0 lds
  buffer_load_dwordx4 v2, s[28:31], s22 offen offset:1024 lds
  buffer_load_dwordx4 v2, s[28:31], s22 offen offset:2048 lds
  s_add_u32 m0, s3, 73728
  s_mov_b32 s22, 589824
  buffer_load_dwordx4 v2, s[28:31], s22 offen offset:0 lds
  buffer_load_dwordx4 v2, s[28:31], s22 offen offset:1024 lds
  buffer_load_dwordx4 v2, s[28:31], s22 offen offset:2048 lds
  s_waitcnt lgkmcnt(0)
  s_mul_i32 s52, s52, 0x9E3779B1
  s_add_u32 s52, s52, 0x7F4A7C15
  s_waitcnt vmcnt(15) lgkmcnt(0)
  s_barrier
  s_setprio 3
  ds_read_b128 v[24:27], v12 offset:0
  ds_read_b64_tr_b16 v[40:41], v16 offset:0
  ds_read_b64_tr_b16 v[42:43], v16 offset:512
  ds_read_b64_tr_b16 v[44:45], v16 offset:1024
  ds_read_b64_tr_b16 v[46:47], v16 offset:1536
  ds_read_b64_tr_b16 v[48:49], v16 offset:2048
  ds_read_b64_tr_b16 v[50:51], v16 offset:2560
  ds_read_b128 v[28:31], v13 offset:1024
  ds_read_b64_tr_b16 v[52:53], v16 offset:6144
  ds_read_b64_tr_b16 v[54:55], v16 offset:6656
  ds_read_b64_tr_b16 v[56:57], v16 offset:7168
  ds_read_b64_tr_b16 v[58:59], v16 offset:7680
  ds_read_b64_tr_b16 v[60:61], v16 offset:8192
  ds_read_b64_tr_b16 v[62:63], v16 offset:8704
  .p2align 6
L_qkv_loop:
  s_waitcnt lgkmcnt(7)
  v_mfma_f32_32x32x16_bf16 v[120:135], v[24:27], v[48:51], v[120:135]
  ds_read_b128 v[32:35], v14 offset:2048
  ds_read_b64_tr_b16 v[64:65], v17 offset:0
  ds_read_b64_tr_b16 v[66:67], v17 offset:512
  v_mfma_f32_32x32x16_bf16 v[104:119], v[44:47], v[24:27], v[104:119]
  ds_read_b64_tr_b16 v[68:69], v17 offset:1024
  ds_read_b64_tr_b16 v[70:71], v17 offset:1536
  ds_read_b64_tr_b16 v[72:73], v17 offset:2048
  ds_read_b64_tr_b16 v[74:75], v17 offset:2560
  v_mfma_f32_32x32x16_bf16 v[88:103], v[40:43], v[24:27], v[88:103]
  v_add_u32 v14, 4096, v14
  s_waitcnt lgkmcnt(7)
  v_mfma_f32_32x32x16_bf16 v[120:135], v[28:31], v[60:63], v[120:135]
  ds_read_b128 v[36:39], v15 offset:3072
  ds_read_b64_tr_b16 v[76:77], v17 offset:6144
  ds_read_b64_tr_b16 v[78:79], v17 offset:6656
  v_mfma_f32_32x32x16_bf16 v[104:119], v[56:59], v[28:31], v[104:119]
  ds_read_b64_tr_b16 v[80:81], v17 offset:7168
  ds_read_b64_tr_b16 v[82:83], v17 offset:7680
  ds_read_b64_tr_b16 v[84:85], v17 offset:8192
  ds_read_b64_tr_b16 v[86:87], v17 offset:8704
  v_mfma_f32_32x32x16_bf16 v[88:103], v[52:55], v[28:31], v[88:103]
  s_add_u32 s13, s13, 24576
  s_cmp_ge_u32 s13, 86016
  s_cselect_b32 s58, 86016, 0
  s_sub_u32 s13, s13, s58
  v_add_u32 v17, s13, v16
  v_add_u32 v15, 4096, v15
  s_waitcnt vmcnt(0) lgkmcnt(0)
  s_cmp_eq_u32 s15, 0
  s_cbranch_scc1 L_qkv_nobar
  s_barrier
L_qkv_nobar:
  v_mfma_f32_32x32x16_bf16 v[120:135], v[32:35], v[72:75], v[120:135]
  ds_read_b128 v[24:27], v12 offset:4096
  ds_read_b64_tr_b16 v[40:41], v19 offset:0
  ds_read_b64_tr_b16 v[42:43], v19 offset:512
  v_mfma_f32_32x32x16_bf16 v[104:119], v[68:71], v[32:35], v[104:119]
  ds_read_b64_tr_b16 v[44:45], v19 offset:1024
  ds_read_b64_tr_b16 v[46:47], v19 offset:1536
  ds_read_b64_tr_b16 v[48:49], v19 offset:2048
  ds_read_b64_tr_b16 v[50:51], v19 offset:2560
  v_mfma_f32_32x32x16_bf16 v[88:103], v[64:67], v[32:35], v[88:103]
  v_add_u32 v12, 4096, v12
  s_waitcnt lgkmcnt(7)
  v_mfma_f32_32x32x16_bf16 v[120:135], v[36:39], v[84:87], v[120:135]
  ds_read_b128 v[28:31], v13 offset:5120
  ds_read_b64_tr_b16 v[52:53], v19 offset:6144
  ds_read_b64_tr_b16 v[54:55], v19 offset:6656
  v_mfma_f32_32x32x16_bf16 v[104:119], v[80:83], v[36:39], v[104:119]
  ds_read_b64_tr_b16 v[56:57], v19 offset:7168
  ds_read_b64_tr_b16 v[58:59], v19 offset:7680
  ds_read_b64_tr_b16 v[60:61], v19 offset:8192
  ds_read_b64_tr_b16 v[62:63], v19 offset:8704
  v_mfma_f32_32x32x16_bf16 v[88:103], v[76:79], v[36:39], v[88:103]
  s_add_u32 s14, s14, 24576
  s_cmp_ge_u32 s14, 86016
  s_cselect_b32 s58, 86016, 0
  s_sub_u32 s14, s14, s58
  v_add_u32 v19, s14, v16
  v_add_u32 v13, 4096, v13
  s_sub_u32 s15, s15, 1
  s_cbranch_scc0 L_qkv_loop
  v_mov_b32 v4, 1
  s_mov_b64 exec, 1
  ds_add_u32 v3, v4 offset:0
  s_mov_b64 exec, -1
  v_cvt_pk_bf16_f32 v136, v120, v121
  v_cvt_pk_bf16_f32 v137, v122, v123
  v_cvt_pk_bf16_f32 v138, v124, v125
  v_cvt_pk_bf16_f32 v139, v126, v127
  buffer_store_dwordx4 v[136:139], v18, s[48:51], s10 offen offset:1024 sc1
  v_cvt_pk_bf16_f32 v140, v128, v129
  v_cvt_pk_bf16_f32 v141, v130, v131
  v_cvt_pk_bf16_f32 v142, v132, v133
  v_cvt_pk_bf16_f32 v143, v134, v135
  buffer_store_dwordx4 v[140:143], v18, s[48:51], s10 offen offset:1536 sc1
  v_cvt_pk_bf16_f32 v144, v104, v105
  v_cvt_pk_bf16_f32 v145, v106, v107
  v_cvt_pk_bf16_f32 v146, v108, v109
  v_cvt_pk_bf16_f32 v147, v110, v111
  buffer_store_dwordx4 v[144:147], v11, s[48:51], s10 offen  sc1
  v_cvt_pk_bf16_f32 v148, v112, v113
  v_cvt_pk_bf16_f32 v149, v114, v115
  v_cvt_pk_bf16_f32 v150, v116, v117
  v_cvt_pk_bf16_f32 v151, v118, v119
  buffer_store_dwordx4 v[148:151], v11, s[48:51], s11 offen  sc1
  v_mul_f32 v88, s12, v88
  v_mul_f32 v89, s12, v89
  v_mul_f32 v90, s12, v90
  v_mul_f32 v91, s12, v91
  v_mul_f32 v92, s12, v92
  v_mul_f32 v93, s12, v93
  v_mul_f32 v94, s12, v94
  v_mul_f32 v95, s12, v95
  v_cvt_pk_bf16_f32 v152, v88, v89
  v_cvt_pk_bf16_f32 v153, v90, v91
  v_cvt_pk_bf16_f32 v154, v92, v93
  v_cvt_pk_bf16_f32 v155, v94, v95
  buffer_store_dwordx4 v[152:155], v11, s[48:51], s8 offen  sc1
  v_mul_f32 v96, s12, v96
  v_mul_f32 v97, s12, v97
  v_mul_f32 v98, s12, v98
  v_mul_f32 v99, s12, v99
  v_mul_f32 v100, s12, v100
  v_mul_f32 v101, s12, v101
  v_mul_f32 v102, s12, v102
  v_mul_f32 v103, s12, v103
  v_cvt_pk_bf16_f32 v156, v96, v97
  v_cvt_pk_bf16_f32 v157, v98, v99
  v_cvt_pk_bf16_f32 v158, v100, v101
  v_cvt_pk_bf16_f32 v159, v102, v103
  buffer_store_dwordx4 v[156:159], v11, s[48:51], s9 offen  sc1
  s_branch L_ffn
L_att:
  s_and_b32 s4, s57, 3
  s_lshl_b32 s5, s56, 2
  s_add_u32 s4, s4, s5
  s_lshr_b32 s5, s57, 2
  s_and_b32 s6, s53, 3
  s_lshr_b32 s7, s53, 2
  s_lshl_b32 s8, s5, 3
  s_lshl_b32 s58, s7, 2
  s_add_u32 s8, s8, s58
  s_lshl_b32 s9, s4, 16
  s_lshl_b32 s10, s4, 17
  s_add_u32 s10, s10, 2097152
  s_lshl_b32 s11, s6, 15
  s_add_u32 s11, s11, s10
  v_lshlrev_b32 v2, 4, v1
  v_and_b32 v5, 15, v1
  v_lshrrev_b32 v6, 5, v1
  v_lshlrev_b32 v6, 8, v6
  v_lshl_add_u32 v4, v5, 4, v6
  v_and_b32 v5, 27, v1
  v_cmp_eq_u32 vcc, 16, v5
  v_mov_b32 v6, 0x3f803f80
  s_mov_b32 s12, 0xffff
  s_mov_b32 s13, 0xffff
  v_cndmask_b32 v5, 0, v6, vcc
  s_add_u32 s58, s6, 1
  s_and_b32 s58, s58, 3
  s_add_u32 s58, s58, s8
  s_lshl_b32 s58, s58, 10
  s_add_u32 s16, s58, s9
  s_add_u32 s58, s6, 2
  s_and_b32 s58, s58, 3
  s_add_u32 s58, s58, s8
  s_lshl_b32 s58, s58, 10
  s_add_u32 s17, s58, s9
  s_add_u32 s58, s6, 3
  s_and_b32 s58, s58, 3
  s_add_u32 s58, s58, s8
  s_lshl_b32 s58, s58, 10
  s_add_u32 s18, s58, s9
  s_add_u32 s58, s6, 4
  s_and_b32 s58, s58, 3
  s_add_u32 s58, s58, s8
  s_lshl_b32 s58, s58, 10
  s_add_u32 s19, s58, s9
  s_add_u32 s58, s6, 1
  s_and_b32 s58, s58, 3
  s_lshl_b32 s59, s7, 2
  s_add_u32 s58, s58, s59
  s_mul_i32 s58, s58, 6912
  s_add_u32 s58, s58, 0
  v_add_u32 v152, s58, v2
  v_lshl_add_u32 v153, v1, 2, s58
  s_add_u32 s58, s6, 2
  s_and_b32 s58, s58, 3
  s_lshl_b32 s59, s7, 2
  s_add_u32 s58, s58, s59
  s_mul_i32 s58, s58, 6912
  s_add_u32 s58, s58, 2304
  v_add_u32 v154, s58, v2
  v_lshl_add_u32 v155, v1, 2, s58
  s_add_u32 s58, s6, 3
  s_and_b32 s58, s58, 3
  s_lshl_b32 s59, s7, 2
  s_add_u32 s58, s58, s59
  s_mul_i32 s58, s58, 6912
  s_add_u32 s58, s58, 4608
  v_add_u32 v156, s58, v2
  v_lshl_add_u32 v157, v1, 2, s58
  s_mul_i32 s58, s53, 6912
  v_add_u32 v158, s58, v2
  v_lshl_add_u32 v159, v1, 2, s58
  s_add_u32 s15, s8, s6
  s_lshl_b32 s98, s15, 15
  s_lshl_b32 s58, s4, 10
  s_add_u32 s98, s98, s58
  s_add_u32 s98, s98, 8388608
  s_lshl_b32 s99, s15, 12
  s_lshl_b32 s58, s4, 7
  s_add_u32 s99, s99, s58
  s_add_u32 s99, s99, 26214400
  s_lshl_b32 s58, s6, 2
  v_add_u32 v160, s58, v3
  v_mov_b32 v161, 1
  v_mov_b32 v32, v5
  v_mov_b32 v33, v5
  v_mov_b32 v34, v5
  v_mov_b32 v35, v5
  v_mov_b32 v36, v5
  v_mov_b32 v37, v5
  v_mov_b32 v38, v5
  v_mov_b32 v39, v5
  v_mov_b32 v40, v5
  v_mov_b32 v41, v5
  v_mov_b32 v42, v5
  v_mov_b32 v43, v5
  v_mov_b32 v44, v5
  v_mov_b32 v45, v5
  v_mov_b32 v46, v5
  v_mov_b32 v47, v5
  v_mov_b32 v88, 0
  v_mov_b32 v89, 0
  v_mov_b32 v90, 0
  v_mov_b32 v91, 0
  v_mov_b32 v92, 0
  v_mov_b32 v93, 0
  v_mov_b32 v94, 0
  v_mov_b32 v95, 0
  v_mov_b32 v96, 0
  v_mov_b32 v97, 0
  v_mov_b32 v98, 0
  v_mov_b32 v99, 0
  v_mov_b32 v100, 0
  v_mov_b32 v101, 0
  v_mov_b32 v102, 0
  v_mov_b32 v103, 0
  v_mov_b32 v104, 0
  v_mov_b32 v105, 0
  v_mov_b32 v106, 0
  v_mov_b32 v107, 0
  v_mov_b32 v108, 0
  v_mov_b32 v109, 0
  v_mov_b32 v110, 0
  v_mov_b32 v111, 0
  v_mov_b32 v112, 0
  v_mov_b32 v113, 0
  v_mov_b32 v114, 0
  v_mov_b32 v115, 0
  v_mov_b32 v116, 0
  v_mov_b32 v117, 0
  v_mov_b32 v118, 0
  v_mov_b32 v119, 0
  v_mov_b32 v120, 0
  v_mov_b32 v121, 0
  v_mov_b32 v122, 0
  v_mov_b32 v123, 0
  v_mov_b32 v124, 0
  v_mov_b32 v125, 0
  v_mov_b32 v126, 0
  v_mov_b32 v127, 0
  v_mov_b32 v128, 0
  v_mov_b32 v129, 0
  v_mov_b32 v130, 0
  v_mov_b32 v131, 0
  v_mov_b32 v132, 0
  v_mov_b32 v133, 0
  v_mov_b32 v134, 0
  v_mov_b32 v135, 0
  v_mov_b32 v136, 0
  v_mov_b32 v137, 0
  v_mov_b32 v138, 0
  v_mov_b32 v139, 0
  v_mov_b32 v140, 0
  v_mov_b32 v141, 0
  v_mov_b32 v142, 0
  v_mov_b32 v143, 0
  v_mov_b32 v144, 0
  v_mov_b32 v145, 0
  v_mov_b32 v146, 0
  v_mov_b32 v147, 0
  v_mov_b32 v148, 0
  v_mov_b32 v149, 0
  v_mov_b32 v150, 0
  v_mov_b32 v151, 0
  v_mov_b32 v84, 0
  v_mov_b32 v85, 0
  v_mov_b32 v86, 0
  v_mov_b32 v87, 0
  v_mov_b32 v78, 0
  v_mov_b32 v79, 0
  s_cmp_eq_u32 s53, 0
  s_cbranch_scc0 L_att_wait
  s_lshl_b32 s58, s56, 12
  s_add_u32 s58, s58, 25165824
  v_lshlrev_b32 v6, 7, v1
  s_mov_b32 s61, 524288
recurrent_scan__softmax_full_mha__dense_activation_relu__prompt_kernel_lp1:
  ds_read_b32 v5, v3 offset:16
  s_waitcnt lgkmcnt(0)
  v_readfirstlane_b32 s60, v5
  s_sub_u32 s61, s61, 1
  s_cbranch_scc1 recurrent_scan__softmax_full_mha__dense_activation_relu__prompt_kernel_lpd2
  s_cmp_ge_u32 s60, 4
  s_cbranch_scc1 recurrent_scan__softmax_full_mha__dense_activation_relu__prompt_kernel_lpd2
  s_sleep 2
  s_branch recurrent_scan__softmax_full_mha__dense_activation_relu__prompt_kernel_lp1
recurrent_scan__softmax_full_mha__dense_activation_relu__prompt_kernel_lpd2:
  s_sleep 32
  s_mov_b64 exec, 0xffffffff
  s_mov_b32 s61, 524288
recurrent_scan__softmax_full_mha__dense_activation_relu__prompt_kernel_p13:
  buffer_load_dword v7, v6, s[48:51], s58 offen sc1
  s_waitcnt vmcnt(0)
  v_cmp_ne_u32 vcc, s52, v7
  s_sub_u32 s61, s61, 1
  s_cbranch_scc1 recurrent_scan__softmax_full_mha__dense_activation_relu__prompt_kernel_p1d4
  s_cmp_eq_u64 vcc, 0
  s_cbranch_scc1 recurrent_scan__softmax_full_mha__dense_activation_relu__prompt_kernel_p1d4
  s_mov_b64 exec, vcc
  s_sleep 2
  s_branch recurrent_scan__softmax_full_mha__dense_activation_relu__prompt_kernel_p13
recurrent_scan__softmax_full_mha__dense_activation_relu__prompt_kernel_p1d4:
  s_mov_b64 exec, -1
  v_mov_b32 v5, 1
  ds_write_b32 v3, v5 offset:12
  s_branch L_att_go
L_att_wait:
  s_mov_b32 s61, 524288
recurrent_scan__softmax_full_mha__dense_activation_relu__prompt_kernel_go5:
  ds_read_b32 v5, v3 offset:12
  s_waitcnt lgkmcnt(0)
  v_readfirstlane_b32 s60, v5
  s_sub_u32 s61, s61, 1
  s_cbranch_scc1 recurrent_scan__softmax_full_mha__dense_activation_relu__prompt_kernel_god6
  s_cmp_ge_u32 s60, 1
  s_cbranch_scc1 recurrent_scan__softmax_full_mha__dense_activation_relu__prompt_kernel_god6
  s_sleep 1
  s_branch recurrent_scan__softmax_full_mha__dense_activation_relu__prompt_kernel_go5
recurrent_scan__softmax_full_mha__dense_activation_relu__prompt_kernel_god6:
L_att_go:
  buffer_load_dwordx4 v[24:27], v2, s[48:51], s11 offen sc1
  buffer_load_dwordx4 v[8:11], v2, s[48:51], s16 offen sc1
  buffer_load_dwordx4 v[12:15], v2, s[48:51], s17 offen sc1
  s_mov_b64 exec, s[12:13]
  buffer_load_dwordx4 v[32:35], v4, s[48:51], s11 offen offset:1024 sc1
  buffer_load_dwordx4 v[36:39], v4, s[48:51], s11 offen offset:1536 sc1
  s_mov_b64 exec, -1
  buffer_load_dwordx4 v[16:19], v2, s[48:51], s18 offen sc1
  buffer_load_dwordx4 v[20:23], v2, s[48:51], s19 offen sc1
  s_add_u32 s11, s11, 2048
  s_mov_b32 s14, 8
  buffer_load_dwordx4 v[28:31], v2, s[48:51], s11 offen sc1
  s_waitcnt vmcnt(6)
  v_mfma_f32_32x32x16_bf16 v[48:63], v[24:27], v[8:11], 0
  s_waitcnt vmcnt(1)
  s_nop 7
  s_nop 3
  s_cmp_lt_u32 s53, 4
  s_cbranch_scc1 L_att_loop
  s_mov_b32 s14, 6
  s_setprio 1
  .p2align 6
L_att_loopA:
  v_exp_f32 v48, v48
  v_cvt_pk_bf16_f32 v87, v78, v79
  v_exp_f32 v49, v49
  v_exp_f32 v50, v50
  v_mfma_f32_32x32x16_bf16 v[136:151], v[44:47], v[84:87], v[136:151]
  v_exp_f32 v51, v51
  v_cvt_pk_bf16_f32 v80, v48, v49
  v_exp_f32 v52, v52
  v_exp_f32 v53, v53
  v_cvt_pk_bf16_f32 v81, v50, v51
  v_exp_f32 v54, v54
  v_exp_f32 v55, v55
  v_mfma_f32_32x32x16_bf16 v[64:79], v[24:27], v[12:15], 0
  s_mov_b64 exec, s[12:13]
  buffer_load_dwordx4 v[40:43], v4, s[48:51], s11 offen offset:1024 sc1
  buffer_load_dwordx4 v[44:47], v4, s[48:51], s11 offen offset:1536 sc1
  s_mov_b64 exec, -1
  s_add_u32 s11, s11, 2048
  s_setprio 2
  v_cvt_pk_bf16_f32 v82, v52, v53
  v_exp_f32 v56, v56
  v_exp_f32 v57, v57
  v_cvt_pk_bf16_f32 v83, v54, v55
  v_exp_f32 v58, v58
  v_exp_f32 v59, v59
  s_waitcnt vmcnt(3)
  v_mfma_f32_32x32x16_bf16 v[88:103], v[32:35], v[80:83], v[88:103]
  v_cvt_pk_bf16_f32 v84, v56, v57
  v_exp_f32 v60, v60
  v_exp_f32 v61, v61
  v_cvt_pk_bf16_f32 v85, v58, v59
  v_exp_f32 v62, v62
  v_exp_f32 v63, v63
  v_cvt_pk_bf16_f32 v86, v60, v61
  s_setprio 1
  v_exp_f32 v64, v64
  v_cvt_pk_bf16_f32 v87, v62, v63
  v_exp_f32 v65, v65
  v_exp_f32 v66, v66
  v_mfma_f32_32x32x16_bf16 v[88:103], v[36:39], v[84:87], v[88:103]
  v_exp_f32 v67, v67
  v_cvt_pk_bf16_f32 v80, v64, v65
  v_exp_f32 v68, v68
  v_exp_f32 v69, v69
  v_cvt_pk_bf16_f32 v81, v66, v67
  v_exp_f32 v70, v70
  v_exp_f32 v71, v71
  v_mfma_f32_32x32x16_bf16 v[48:63], v[24:27], v[16:19], 0
  s_setprio 2
  v_cvt_pk_bf16_f32 v82, v68, v69
  v_exp_f32 v72, v72
  v_exp_f32 v73, v73
  v_cvt_pk_bf16_f32 v83, v70, v71
  v_exp_f32 v74, v74
  v_exp_f32 v75, v75
  v_mfma_f32_32x32x16_bf16 v[104:119], v[32:35], v[80:83], v[104:119]
  v_cvt_pk_bf16_f32 v84, v72, v73
  v_exp_f32 v76, v76
  v_exp_f32 v77, v77
  v_cvt_pk_bf16_f32 v85, v74, v75
  v_exp_f32 v78, v78
  v_exp_f32 v79, v79
  v_cvt_pk_bf16_f32 v86, v76, v77
  s_setprio 1
  v_exp_f32 v48, v48
  v_cvt_pk_bf16_f32 v87, v78, v79
  v_exp_f32 v49, v49
  v_exp_f32 v50, v50
  v_mfma_f32_32x32x16_bf16 v[104:119], v[36:39], v[84:87], v[104:119]
  v_exp_f32 v51, v51
  v_cvt_pk_bf16_f32 v80, v48, v49
  v_exp_f32 v52, v52
  v_exp_f32 v53, v53
  v_cvt_pk_bf16_f32 v81, v50, v51
  v_exp_f32 v54, v54
  v_exp_f32 v55, v55
  v_mfma_f32_32x32x16_bf16 v[64:79], v[24:27], v[20:23], 0
  s_setprio 2
  v_cvt_pk_bf16_f32 v82, v52, v53
  v_exp_f32 v56, v56
  v_exp_f32 v57, v57
  v_cvt_pk_bf16_f32 v83, v54, v55
  v_exp_f32 v58, v58
  v_exp_f32 v59, v59
  v_mfma_f32_32x32x16_bf16 v[120:135], v[32:35], v[80:83], v[120:135]
  v_cvt_pk_bf16_f32 v84, v56, v57
  v_exp_f32 v60, v60
  v_exp_f32 v61, v61
  v_cvt_pk_bf16_f32 v85, v58, v59
  v_exp_f32 v62, v62
  v_exp_f32 v63, v63
  v_cvt_pk_bf16_f32 v86, v60, v61
  s_setprio 1
  v_exp_f32 v64, v64
  v_cvt_pk_bf16_f32 v87, v62, v63
  v_exp_f32 v65, v65
  v_exp_f32 v66, v66
  v_mfma_f32_32x32x16_bf16 v[120:135], v[36:39], v[84:87], v[120:135]
  v_exp_f32 v67, v67
  v_cvt_pk_bf16_f32 v80, v64, v65
  v_exp_f32 v68, v68
  v_exp_f32 v69, v69
  v_cvt_pk_bf16_f32 v81, v66, v67
  v_exp_f32 v70, v70
  v_exp_f32 v71, v71
  s_waitcnt vmcnt(2)
  v_mfma_f32_32x32x16_bf16 v[48:63], v[28:31], v[8:11], 0
  buffer_load_dwordx4 v[24:27], v2, s[48:51], s11 offen sc1
  s_setprio 2
  v_cvt_pk_bf16_f32 v82, v68, v69
  v_exp_f32 v72, v72
  v_exp_f32 v73, v73
  v_cvt_pk_bf16_f32 v83, v70, v71
  v_exp_f32 v74, v74
  v_exp_f32 v75, v75
  v_mfma_f32_32x32x16_bf16 v[136:151], v[32:35], v[80:83], v[136:151]
  v_cvt_pk_bf16_f32 v84, v72, v73
  v_exp_f32 v76, v76
  v_exp_f32 v77, v77
  v_cvt_pk_bf16_f32 v85, v74, v75
  v_exp_f32 v78, v78
  v_exp_f32 v79, v79
  v_cvt_pk_bf16_f32 v86, v76, v77
  s_setprio 1
  v_exp_f32 v48, v48
  v_cvt_pk_bf16_f32 v87, v78, v79
  v_exp_f32 v49, v49
  v_exp_f32 v50, v50
  v_mfma_f32_32x32x16_bf16 v[136:151], v[36:39], v[84:87], v[136:151]
  v_exp_f32 v51, v51
  v_cvt_pk_bf16_f32 v80, v48, v49
  v_exp_f32 v52, v52
  v_exp_f32 v53, v53
  v_cvt_pk_bf16_f32 v81, v50, v51
  v_exp_f32 v54, v54
  v_exp_f32 v55, v55
  v_mfma_f32_32x32x16_bf16 v[64:79], v[28:31], v[12:15], 0
  s_mov_b64 exec, s[12:13]
  buffer_load_dwordx4 v[32:35], v4, s[48:51], s11 offen offset:1024 sc1
  buffer_load_dwordx4 v[36:39], v4, s[48:51], s11 offen offset:1536 sc1
  s_mov_b64 exec, 1
  ds_add_u32 v160, v161 offset:48
  s_mov_b64 exec, -1
  s_add_u32 s11, s11, 2048
  s_setprio 2
  v_cvt_pk_bf16_f32 v82, v52, v53
  v_exp_f32 v56, v56
  v_exp_f32 v57, v57
  v_cvt_pk_bf16_f32 v83, v54, v55
  v_exp_f32 v58, v58
  v_exp_f32 v59, v59
  s_waitcnt vmcnt(3)
  v_mfma_f32_32x32x16_bf16 v[88:103], v[40:43], v[80:83], v[88:103]
  v_cvt_pk_bf16_f32 v84, v56, v57
  v_exp_f32 v60, v60
  v_exp_f32 v61, v61
  v_cvt_pk_bf16_f32 v85, v58, v59
  v_exp_f32 v62, v62
  v_exp_f32 v63, v63
  v_cvt_pk_bf16_f32 v86, v60, v61
  s_setprio 1
  v_exp_f32 v64, v64
  v_cvt_pk_bf16_f32 v87, v62, v63
  v_exp_f32 v65, v65
  v_exp_f32 v66, v66
  v_mfma_f32_32x32x16_bf16 v[88:103], v[44:47], v[84:87], v[88:103]
  v_exp_f32 v67, v67
  v_cvt_pk_bf16_f32 v80, v64, v65
  v_exp_f32 v68, v68
  v_exp_f32 v69, v69
  v_cvt_pk_bf16_f32 v81, v66, v67
  v_exp_f32 v70, v70
  v_exp_f32 v71, v71
  v_mfma_f32_32x32x16_bf16 v[48:63], v[28:31], v[16:19], 0
  s_setprio 2
  v_cvt_pk_bf16_f32 v82, v68, v69
  v_exp_f32 v72, v72
  v_exp_f32 v73, v73
  v_cvt_pk_bf16_f32 v83, v70, v71
  v_exp_f32 v74, v74
  v_exp_f32 v75, v75
  v_mfma_f32_32x32x16_bf16 v[104:119], v[40:43], v[80:83], v[104:119]
  v_cvt_pk_bf16_f32 v84, v72, v73
  v_exp_f32 v76, v76
  v_exp_f32 v77, v77
  v_cvt_pk_bf16_f32 v85, v74, v75
  v_exp_f32 v78, v78
  v_exp_f32 v79, v79
  v_cvt_pk_bf16_f32 v86, v76, v77
  s_setprio 1
  v_exp_f32 v48, v48
  v_cvt_pk_bf16_f32 v87, v78, v79
  v_exp_f32 v49, v49
  v_exp_f32 v50, v50
  v_mfma_f32_32x32x16_bf16 v[104:119], v[44:47], v[84:87], v[104:119]
  v_exp_f32 v51, v51
  v_cvt_pk_bf16_f32 v80, v48, v49
  v_exp_f32 v52, v52
  v_exp_f32 v53, v53
  v_cvt_pk_bf16_f32 v81, v50, v51
  v_exp_f32 v54, v54
  v_exp_f32 v55, v55
  v_mfma_f32_32x32x16_bf16 v[64:79], v[28:31], v[20:23], 0
  s_setprio 2
  v_cvt_pk_bf16_f32 v82, v52, v53
  v_exp_f32 v56, v56
  v_exp_f32 v57, v57
  v_cvt_pk_bf16_f32 v83, v54, v55
  v_exp_f32 v58, v58
  v_exp_f32 v59, v59
  v_mfma_f32_32x32x16_bf16 v[120:135], v[40:43], v[80:83], v[120:135]
  v_cvt_pk_bf16_f32 v84, v56, v57
  v_exp_f32 v60, v60
  v_exp_f32 v61, v61
  v_cvt_pk_bf16_f32 v85, v58, v59
  v_exp_f32 v62, v62
  v_exp_f32 v63, v63
  v_cvt_pk_bf16_f32 v86, v60, v61
  s_setprio 1
  v_exp_f32 v64, v64
  v_cvt_pk_bf16_f32 v87, v62, v63
  v_exp_f32 v65, v65
  v_exp_f32 v66, v66
  v_mfma_f32_32x32x16_bf16 v[120:135], v[44:47], v[84:87], v[120:135]
  v_exp_f32 v67, v67
  v_cvt_pk_bf16_f32 v80, v64, v65
  v_exp_f32 v68, v68
  v_exp_f32 v69, v69
  v_cvt_pk_bf16_f32 v81, v66, v67
  v_exp_f32 v70, v70
  v_exp_f32 v71, v71
  s_waitcnt vmcnt(2)
  v_mfma_f32_32x32x16_bf16 v[48:63], v[24:27], v[8:11], 0
  buffer_load_dwordx4 v[28:31], v2, s[48:51], s11 offen sc1
  s_setprio 2
  v_cvt_pk_bf16_f32 v82, v68, v69
  v_exp_f32 v72, v72
  v_exp_f32 v73, v73
  v_cvt_pk_bf16_f32 v83, v70, v71
  v_exp_f32 v74, v74
  v_exp_f32 v75, v75
  v_mfma_f32_32x32x16_bf16 v[136:151], v[40:43], v[80:83], v[136:151]
  s_sub_u32 s14, s14, 1
  s_cmp_lg_u32 s14, 0
  v_cvt_pk_bf16_f32 v84, v72, v73
  v_exp_f32 v76, v76
  v_exp_f32 v77, v77
  v_cvt_pk_bf16_f32 v85, v74, v75
  v_exp_f32 v78, v78
  v_exp_f32 v79, v79
  v_cvt_pk_bf16_f32 v86, v76, v77
  s_setprio 1
  s_cbranch_scc1 L_att_loopA
  s_mov_b32 s14, 2
  s_setprio 0
  .p2align 6
L_att_loop:
  v_exp_f32 v48, v48
  v_cvt_pk_bf16_f32 v87, v78, v79
  v_exp_f32 v49, v49
  v_exp_f32 v50, v50
  v_mfma_f32_32x32x16_bf16 v[136:151], v[44:47], v[84:87], v[136:151]
  v_exp_f32 v51, v51
  v_cvt_pk_bf16_f32 v80, v48, v49
  v_exp_f32 v52, v52
  v_exp_f32 v53, v53
  v_cvt_pk_bf16_f32 v81, v50, v51
  v_exp_f32 v54, v54
  v_exp_f32 v55, v55
  v_mfma_f32_32x32x16_bf16 v[64:79], v[24:27], v[12:15], 0
  s_mov_b64 exec, s[12:13]
  buffer_load_dwordx4 v[40:43], v4, s[48:51], s11 offen offset:1024 sc1
  buffer_load_dwordx4 v[44:47], v4, s[48:51], s11 offen offset:1536 sc1
  s_mov_b64 exec, -1
  s_add_u32 s11, s11, 2048
  s_setprio 1
  v_cvt_pk_bf16_f32 v82, v52, v53
  v_exp_f32 v56, v56
  v_exp_f32 v57, v57
  v_cvt_pk_bf16_f32 v83, v54, v55
  v_exp_f32 v58, v58
  v_exp_f32 v59, v59
  s_waitcnt vmcnt(3)
  v_mfma_f32_32x32x16_bf16 v[88:103], v[32:35], v[80:83], v[88:103]
  v_cvt_pk_bf16_f32 v84, v56, v57
  v_exp_f32 v60, v60
  v_exp_f32 v61, v61
  v_cvt_pk_bf16_f32 v85, v58, v59
  v_exp_f32 v62, v62
  v_exp_f32 v63, v63
  v_cvt_pk_bf16_f32 v86, v60, v61
  s_setprio 0
  v_exp_f32 v64, v64
  v_cvt_pk_bf16_f32 v87, v62, v63
  v_exp_f32 v65, v65
  v_exp_f32 v66, v66
  v_mfma_f32_32x32x16_bf16 v[88:103], v[36:39], v[84:87], v[88:103]
  v_exp_f32 v67, v67
  v_cvt_pk_bf16_f32 v80, v64, v65
  v_exp_f32 v68, v68
  v_exp_f32 v69, v69
  v_cvt_pk_bf16_f32 v81, v66, v67
  v_exp_f32 v70, v70
  v_exp_f32 v71, v71
  v_mfma_f32_32x32x16_bf16 v[48:63], v[24:27], v[16:19], 0
  s_setprio 1
  v_cvt_pk_bf16_f32 v82, v68, v69
  v_exp_f32 v72, v72
  v_exp_f32 v73, v73
  v_cvt_pk_bf16_f32 v83, v70, v71
  v_exp_f32 v74, v74
  v_exp_f32 v75, v75
  v_mfma_f32_32x32x16_bf16 v[104:119], v[32:35], v[80:83], v[104:119]
  v_cvt_pk_bf16_f32 v84, v72, v73
  v_exp_f32 v76, v76
  v_exp_f32 v77, v77
  v_cvt_pk_bf16_f32 v85, v74, v75
  v_exp_f32 v78, v78
  v_exp_f32 v79, v79
  v_cvt_pk_bf16_f32 v86, v76, v77
  s_setprio 0
  v_exp_f32 v48, v48
  v_cvt_pk_bf16_f32 v87, v78, v79
  v_exp_f32 v49, v49
  v_exp_f32 v50, v50
  v_mfma_f32_32x32x16_bf16 v[104:119], v[36:39], v[84:87], v[104:119]
  v_exp_f32 v51, v51
  v_cvt_pk_bf16_f32 v80, v48, v49
  v_exp_f32 v52, v52
  v_exp_f32 v53, v53
  v_cvt_pk_bf16_f32 v81, v50, v51
  v_exp_f32 v54, v54
  v_exp_f32 v55, v55
  v_mfma_f32_32x32x16_bf16 v[64:79], v[24:27], v[20:23], 0
  s_setprio 1
  v_cvt_pk_bf16_f32 v82, v52, v53
  v_exp_f32 v56, v56
  v_exp_f32 v57, v57
  v_cvt_pk_bf16_f32 v83, v54, v55
  v_exp_f32 v58, v58
  v_exp_f32 v59, v59
  v_mfma_f32_32x32x16_bf16 v[120:135], v[32:35], v[80:83], v[120:135]
  v_cvt_pk_bf16_f32 v84, v56, v57
  v_exp_f32 v60, v60
  v_exp_f32 v61, v61
  v_cvt_pk_bf16_f32 v85, v58, v59
  v_exp_f32 v62, v62
  v_exp_f32 v63, v63
  v_cvt_pk_bf16_f32 v86, v60, v61
  s_setprio 0
  v_exp_f32 v64, v64
  v_cvt_pk_bf16_f32 v87, v62, v63
  v_exp_f32 v65, v65
  v_exp_f32 v66, v66
  v_mfma_f32_32x32x16_bf16 v[120:135], v[36:39], v[84:87], v[120:135]
  v_exp_f32 v67, v67
  v_cvt_pk_bf16_f32 v80, v64, v65
  v_exp_f32 v68, v68
  v_exp_f32 v69, v69
  v_cvt_pk_bf16_f32 v81, v66, v67
  v_exp_f32 v70, v70
  v_exp_f32 v71, v71
  s_waitcnt vmcnt(2)
  v_mfma_f32_32x32x16_bf16 v[48:63], v[28:31], v[8:11], 0
  buffer_load_dwordx4 v[24:27], v2, s[48:51], s11 offen sc1
  s_setprio 1
  v_cvt_pk_bf16_f32 v82, v68, v69
  v_exp_f32 v72, v72
  v_exp_f32 v73, v73
  v_cvt_pk_bf16_f32 v83, v70, v71
  v_exp_f32 v74, v74
  v_exp_f32 v75, v75
  v_mfma_f32_32x32x16_bf16 v[136:151], v[32:35], v[80:83], v[136:151]
  s_sub_u32 s14, s14, 1
  s_cmp_lg_u32 s14, 0
  v_cvt_pk_bf16_f32 v84, v72, v73
  v_exp_f32 v76, v76
  v_exp_f32 v77, v77
  v_cvt_pk_bf16_f32 v85, v74, v75
  v_exp_f32 v78, v78
  v_exp_f32 v79, v79
  v_cvt_pk_bf16_f32 v86, v76, v77
  s_setprio 0
  s_cbranch_scc0 L_att_last
  v_exp_f32 v48, v48
  v_cvt_pk_bf16_f32 v87, v78, v79
  v_exp_f32 v49, v49
  v_exp_f32 v50, v50
  v_mfma_f32_32x32x16_bf16 v[136:151], v[36:39], v[84:87], v[136:151]
  v_exp_f32 v51, v51
  v_cvt_pk_bf16_f32 v80, v48, v49
  v_exp_f32 v52, v52
  v_exp_f32 v53, v53
  v_cvt_pk_bf16_f32 v81, v50, v51
  v_exp_f32 v54, v54
  v_exp_f32 v55, v55
  v_mfma_f32_32x32x16_bf16 v[64:79], v[28:31], v[12:15], 0
  s_mov_b64 exec, s[12:13]
  buffer_load_dwordx4 v[32:35], v4, s[48:51], s11 offen offset:1024 sc1
  buffer_load_dwordx4 v[36:39], v4, s[48:51], s11 offen offset:1536 sc1
  s_mov_b64 exec, 1
  ds_add_u32 v160, v161 offset:48
  s_mov_b64 exec, -1
  s_add_u32 s11, s11, 2048
  s_setprio 1
  v_cvt_pk_bf16_f32 v82, v52, v53
  v_exp_f32 v56, v56
  v_exp_f32 v57, v57
  v_cvt_pk_bf16_f32 v83, v54, v55
  v_exp_f32 v58, v58
  v_exp_f32 v59, v59
  s_waitcnt vmcnt(3)
  v_mfma_f32_32x32x16_bf16 v[88:103], v[40:43], v[80:83], v[88:103]
  v_cvt_pk_bf16_f32 v84, v56, v57
  v_exp_f32 v60, v60
  v_exp_f32 v61, v61
  v_cvt_pk_bf16_f32 v85, v58, v59
  v_exp_f32 v62, v62
  v_exp_f32 v63, v63
  v_cvt_pk_bf16_f32 v86, v60, v61
  s_setprio 0
  v_exp_f32 v64, v64
  v_cvt_pk_bf16_f32 v87, v62, v63
  v_exp_f32 v65, v65
  v_exp_f32 v66, v66
  v_mfma_f32_32x32x16_bf16 v[88:103], v[44:47], v[84:87], v[88:103]
  v_exp_f32 v67, v67
  v_cvt_pk_bf16_f32 v80, v64, v65
  v_exp_f32 v68, v68
  v_exp_f32 v69, v69
  v_cvt_pk_bf16_f32 v81, v66, v67
  v_exp_f32 v70, v70
  v_exp_f32 v71, v71
  v_mfma_f32_32x32x16_bf16 v[48:63], v[28:31], v[16:19], 0
  s_setprio 1
  v_cvt_pk_bf16_f32 v82, v68, v69
  v_exp_f32 v72, v72
  v_exp_f32 v73, v73
  v_cvt_pk_bf16_f32 v83, v70, v71
  v_exp_f32 v74, v74
  v_exp_f32 v75, v75
  v_mfma_f32_32x32x16_bf16 v[104:119], v[40:43], v[80:83], v[104:119]
  v_cvt_pk_bf16_f32 v84, v72, v73
  v_exp_f32 v76, v76
  v_exp_f32 v77, v77
  v_cvt_pk_bf16_f32 v85, v74, v75
  v_exp_f32 v78, v78
  v_exp_f32 v79, v79
  v_cvt_pk_bf16_f32 v86, v76, v77
  s_setprio 0
  v_exp_f32 v48, v48
  v_cvt_pk_bf16_f32 v87, v78, v79
  v_exp_f32 v49, v49
  v_exp_f32 v50, v50
  v_mfma_f32_32x32x16_bf16 v[104:119], v[44:47], v[84:87], v[104:119]
  v_exp_f32 v51, v51
  v_cvt_pk_bf16_f32 v80, v48, v49
  v_exp_f32 v52, v52
  v_exp_f32 v53, v53
  v_cvt_pk_bf16_f32 v81, v50, v51
  v_exp_f32 v54, v54
  v_exp_f32 v55, v55
  v_mfma_f32_32x32x16_bf16 v[64:79], v[28:31], v[20:23], 0
  s_setprio 1
  v_cvt_pk_bf16_f32 v82, v52, v53
  v_exp_f32 v56, v56
  v_exp_f32 v57, v57
  v_cvt_pk_bf16_f32 v83, v54, v55
  v_exp_f32 v58, v58
  v_exp_f32 v59, v59
  v_mfma_f32_32x32x16_bf16 v[120:135], v[40:43], v[80:83], v[120:135]
  v_cvt_pk_bf16_f32 v84, v56, v57
  v_exp_f32 v60, v60
  v_exp_f32 v61, v61
  v_cvt_pk_bf16_f32 v85, v58, v59
  v_exp_f32 v62, v62
  v_exp_f32 v63, v63
  v_cvt_pk_bf16_f32 v86, v60, v61
  s_setprio 0
  v_exp_f32 v64, v64
  v_cvt_pk_bf16_f32 v87, v62, v63
  v_exp_f32 v65, v65
  v_exp_f32 v66, v66
  v_mfma_f32_32x32x16_bf16 v[120:135], v[44:47], v[84:87], v[120:135]
  v_exp_f32 v67, v67
  v_cvt_pk_bf16_f32 v80, v64, v65
  v_exp_f32 v68, v68
  v_exp_f32 v69, v69
  v_cvt_pk_bf16_f32 v81, v66, v67
  v_exp_f32 v70, v70
  v_exp_f32 v71, v71
  s_waitcnt vmcnt(2)
  v_mfma_f32_32x32x16_bf16 v[48:63], v[24:27], v[8:11], 0
  buffer_load_dwordx4 v[28:31], v2, s[48:51], s11 offen sc1
  s_setprio 1
  v_cvt_pk_bf16_f32 v82, v68, v69
  v_exp_f32 v72, v72
  v_exp_f32 v73, v73
  v_cvt_pk_bf16_f32 v83, v70, v71
  v_exp_f32 v74, v74
  v_exp_f32 v75, v75
  v_mfma_f32_32x32x16_bf16 v[136:151], v[40:43], v[80:83], v[136:151]
  v_cvt_pk_bf16_f32 v84, v72, v73
  v_exp_f32 v76, v76
  v_exp_f32 v77, v77
  v_cvt_pk_bf16_f32 v85, v74, v75
  v_exp_f32 v78, v78
  v_exp_f32 v79, v79
  v_cvt_pk_bf16_f32 v86, v76, v77
  s_setprio 0
  s_branch L_att_loop
L_att_last:
  v_exp_f32 v48, v48
  v_cvt_pk_bf16_f32 v87, v78, v79
  v_exp_f32 v49, v49
  v_exp_f32 v50, v50
  v_mfma_f32_32x32x16_bf16 v[136:151], v[36:39], v[84:87], v[136:151]
  ds_read_b32 v5, v3 offset:4
  v_exp_f32 v51, v51
  v_cvt_pk_bf16_f32 v80, v48, v49
  v_exp_f32 v52, v52
  v_exp_f32 v53, v53
  v_cvt_pk_bf16_f32 v81, v50, v51
  v_exp_f32 v54, v54
  v_exp_f32 v55, v55
  v_mfma_f32_32x32x16_bf16 v[64:79], v[28:31], v[12:15], 0
  s_setprio 1
  v_cvt_pk_bf16_f32 v82, v52, v53
  v_exp_f32 v56, v56
  v_exp_f32 v57, v57
  v_cvt_pk_bf16_f32 v83, v54, v55
  v_exp_f32 v58, v58
  v_exp_f32 v59, v59
  s_waitcnt vmcnt(1)
  v_mfma_f32_32x32x16_bf16 v[88:103], v[40:43], v[80:83], v[88:103]
  v_cvt_pk_bf16_f32 v84, v56, v57
  v_exp_f32 v60, v60
  v_exp_f32 v61, v61
  v_cvt_pk_bf16_f32 v85, v58, v59
  v_exp_f32 v62, v62
  v_exp_f32 v63, v63
  v_cvt_pk_bf16_f32 v86, v60, v61
  s_setprio 0
  v_exp_f32 v64, v64
  v_cvt_pk_bf16_f32 v87, v62, v63
  v_exp_f32 v65, v65
  v_exp_f32 v66, v66
  v_mfma_f32_32x32x16_bf16 v[88:103], v[44:47], v[84:87], v[88:103]
  s_waitcnt lgkmcnt(0)
  v_readfirstlane_b32 s60, v5
  s_nop 0
  s_cmp_ge_u32 s60, 4
  s_cbranch_scc1 L_xn_free
  s_mov_b32 s61, 524288
recurrent_scan__softmax_full_mha__dense_activation_relu__prompt_kernel_wb7:
  ds_read_b32 v5, v3 offset:4
  s_waitcnt lgkmcnt(0)
  v_readfirstlane_b32 s60, v5
  s_sub_u32 s61, s61, 1
  s_cbranch_scc1 recurrent_scan__softmax_full_mha__dense_activation_relu__prompt_kernel_wbd8
  s_cmp_ge_u32 s60, 4
  s_cbranch_scc1 recurrent_scan__softmax_full_mha__dense_activation_relu__prompt_kernel_wbd8
  s_sleep 2
  s_branch recurrent_scan__softmax_full_mha__dense_activation_relu__prompt_kernel_wb7
recurrent_scan__softmax_full_mha__dense_activation_relu__prompt_kernel_wbd8:
L_xn_free:
  v_exp_f32 v67, v67
  v_cvt_pk_bf16_f32 v80, v64, v65
  v_exp_f32 v68, v68
  v_exp_f32 v69, v69
  v_cvt_pk_bf16_f32 v81, v66, v67
  v_exp_f32 v70, v70
  v_exp_f32 v71, v71
  v_mfma_f32_32x32x16_bf16 v[48:63], v[28:31], v[16:19], 0
  s_setprio 1
  v_cvt_pk_bf16_f32 v82, v68, v69
  v_exp_f32 v72, v72
  v_exp_f32 v73, v73
  v_cvt_pk_bf16_f32 v83, v70, v71
  v_exp_f32 v74, v74
  v_exp_f32 v75, v75
  v_mfma_f32_32x32x16_bf16 v[104:119], v[40:43], v[80:83], v[104:119]
  ds_write_b128 v152, v[88:91]
  ds_write_b128 v152, v[92:95] offset:1024
  ds_write_b32 v153, v96 offset:2048
  v_cvt_pk_bf16_f32 v84, v72, v73
  v_exp_f32 v76, v76
  v_exp_f32 v77, v77
  v_cvt_pk_bf16_f32 v85, v74, v75
  v_exp_f32 v78, v78
  v_exp_f32 v79, v79
  v_cvt_pk_bf16_f32 v86, v76, v77
  s_setprio 0
  v_exp_f32 v48, v48
  v_cvt_pk_bf16_f32 v87, v78, v79
  v_exp_f32 v49, v49
  v_exp_f32 v50, v50
  v_mfma_f32_32x32x16_bf16 v[104:119], v[44:47], v[84:87], v[104:119]
  v_exp_f32 v51, v51
  v_cvt_pk_bf16_f32 v80, v48, v49
  v_exp_f32 v52, v52
  v_exp_f32 v53, v53
  v_cvt_pk_bf16_f32 v81, v50, v51
  v_exp_f32 v54, v54
  v_exp_f32 v55, v55
  v_mfma_f32_32x32x16_bf16 v[64:79], v[28:31], v[20:23], 0
  s_setprio 1
  v_cvt_pk_bf16_f32 v82, v52, v53
  v_exp_f32 v56, v56
  v_exp_f32 v57, v57
  v_cvt_pk_bf16_f32 v83, v54, v55
  v_exp_f32 v58, v58
  v_exp_f32 v59, v59
  v_mfma_f32_32x32x16_bf16 v[120:135], v[40:43], v[80:83], v[120:135]
  ds_write_b128 v154, v[104:107]
  ds_write_b128 v154, v[108:111] offset:1024
  ds_write_b32 v155, v112 offset:2048
  v_cvt_pk_bf16_f32 v84, v56, v57
  v_exp_f32 v60, v60
  v_exp_f32 v61, v61
  v_cvt_pk_bf16_f32 v85, v58, v59
  v_exp_f32 v62, v62
  v_exp_f32 v63, v63
  v_cvt_pk_bf16_f32 v86, v60, v61
  s_setprio 0
  v_exp_f32 v64, v64
  v_cvt_pk_bf16_f32 v87, v62, v63
  v_exp_f32 v65, v65
  v_exp_f32 v66, v66
  v_mfma_f32_32x32x16_bf16 v[120:135], v[44:47], v[84:87], v[120:135]
  v_exp_f32 v67, v67
  v_cvt_pk_bf16_f32 v80, v64, v65
  v_exp_f32 v68, v68
  v_exp_f32 v69, v69
  v_cvt_pk_bf16_f32 v81, v66, v67
  v_exp_f32 v70, v70
  v_exp_f32 v71, v71
  s_setprio 1
  v_cvt_pk_bf16_f32 v82, v68, v69
  v_exp_f32 v72, v72
  v_exp_f32 v73, v73
  v_cvt_pk_bf16_f32 v83, v70, v71
  v_exp_f32 v74, v74
  v_exp_f32 v75, v75
  v_mfma_f32_32x32x16_bf16 v[136:151], v[40:43], v[80:83], v[136:151]
  ds_write_b128 v156, v[120:123]
  ds_write_b128 v156, v[124:127] offset:1024
  ds_write_b32 v157, v128 offset:2048
  v_cvt_pk_bf16_f32 v84, v72, v73
  v_exp_f32 v76, v76
  v_exp_f32 v77, v77
  v_cvt_pk_bf16_f32 v85, v74, v75
  v_exp_f32 v78, v78
  v_exp_f32 v79, v79
  v_cvt_pk_bf16_f32 v86, v76, v77
  s_setprio 0
  v_cvt_pk_bf16_f32 v87, v78, v79
  s_nop 1
  v_mfma_f32_32x32x16_bf16 v[136:151], v[44:47], v[84:87], v[136:151]
  s_setprio 3
  s_waitcnt lgkmcnt(0)
  s_barrier
  ds_read_b32 v72, v159 offset:2048
  ds_read_b32 v73, v159 offset:4352
  ds_read_b32 v74, v159 offset:6656
  ds_read_b128 v[48:51], v158 offset:0
  ds_read_b128 v[52:55], v158 offset:1024
  ds_read_b128 v[56:59], v158 offset:2304
  ds_read_b128 v[60:63], v158 offset:3328
  ds_read_b128 v[64:67], v158 offset:4608
  ds_read_b128 v[68:71], v158 offset:5632
  s_waitcnt lgkmcnt(6)
  v_add_f32 v144, v144, v72
  v_add_f32 v144, v144, v73
  v_add_f32 v144, v144, v74
  v_rcp_f32 v120, v144
  s_waitcnt lgkmcnt(4)
  v_add_f32 v136, v136, v48
  v_add_f32 v137, v137, v49
  v_add_f32 v138, v138, v50
  v_add_f32 v139, v139, v51
  v_add_f32 v140, v140, v52
  v_add_f32 v141, v141, v53
  v_add_f32 v142, v142, v54
  v_add_f32 v143, v143, v55
  s_waitcnt lgkmcnt(2)
  v_add_f32 v136, v136, v56
  v_add_f32 v137, v137, v57
  v_add_f32 v138, v138, v58
  v_add_f32 v139, v139, v59
  v_add_f32 v140, v140, v60
  v_add_f32 v141, v141, v61
  v_add_f32 v142, v142, v62
  v_add_f32 v143, v143, v63
  s_waitcnt lgkmcnt(0)
  v_add_f32 v136, v136, v64
  v_add_f32 v137, v137, v65
  v_add_f32 v138, v138, v66
  v_add_f32 v139, v139, v67
  v_add_f32 v140, v140, v68
  v_add_f32 v141, v141, v69
  v_add_f32 v142, v142, v70
  v_add_f32 v143, v143, v71
  v_mul_f32 v104, v136, v120
  v_mul_f32 v105, v137, v120
  v_mul_f32 v106, v138, v120
  v_mul_f32 v107, v139, v120
  v_mul_f32 v108, v140, v120
  v_mul_f32 v109, v141, v120
  v_mul_f32 v110, v142, v120
  v_mul_f32 v111, v143, v120
  v_cvt_pk_bf16_f32 v80, v104, v105
  v_cvt_pk_bf16_f32 v81, v106, v107
  v_cvt_pk_bf16_f32 v82, v108, v109
  v_cvt_pk_bf16_f32 v83, v110, v111
  buffer_store_dwordx4 v[80:83], v2, s[48:51], s98 offen sc1
  v_max3_f32 v120, abs(v136), abs(v137), abs(v138)
  v_max3_f32 v121, abs(v139), abs(v140), abs(v141)
  v_max3_f32 v120, abs(v142), abs(v143), v120
  v_add_f32 v122, v136, v137
  v_add_f32 v123, v138, v139
  v_add_f32 v124, v140, v141
  v_add_f32 v125, v142, v143
  v_max_f32 v120, v120, v121
  v_add_f32 v122, v122, v123
  v_add_f32 v124, v124, v125
  s_mov_b32 s18, 0x21800000
  s_mov_b32 s19, 0x5d800000
  s_mov_b32 s20, 0x7f000000
  v_add_f32 v122, v122, v124
  v_cmp_le_f32 vcc, s18, v144
  v_cmp_ge_f32 s[22:23], s19, v144
  s_nop 0
  s_and_b64 vcc, vcc, s[22:23]
  v_cmp_gt_f32 s[22:23], s20, v120
  s_nop 0
  s_and_b64 vcc, vcc, s[22:23]
  v_cmp_o_f32 s[22:23], v122, v122
  s_nop 0
  s_and_b64 vcc, vcc, s[22:23]
  s_cmp_eq_u64 vcc, -1
  s_cbranch_scc0 L_att_slow
L_att_fin:
  s_waitcnt vmcnt(0)
  v_mov_b32 v6, s52
  v_mov_b32 v5, 0
  s_mov_b64 exec, 1
  buffer_store_dword v6, v5, s[48:51], s99 offen sc1
  s_mov_b64 exec, -1
  s_cmp_lt_u32 s53, 1
  s_cbranch_scc0 L_att_end
  s_and_b32 s58, s2, 31
  s_lshl_b32 s58, s58, 13
  s_add_u32 s58, s58, 26214400
  v_lshlrev_b32 v5, 7, v1
  s_mov_b32 s61, 524288
  s_mov_b64 s[20:21], 0
  s_sleep 18
L_o_poll:
  s_not_b64 exec, s[20:21]
  buffer_load_dword v6, v5, s[48:51], s58 offen sc1
  s_waitcnt vmcnt(0)
  v_cmp_eq_u32 vcc, s52, v6
  s_mov_b64 exec, -1
  s_or_b64 vcc, vcc, s[20:21]
  s_mov_b64 s[20:21], vcc
  s_sub_u32 s61, s61, 1
  s_cselect_b64 vcc, -1, vcc
  v_mov_b32 v8, vcc_lo
  v_mov_b32 v9, vcc_hi
  s_mov_b64 exec, 1
  ds_or_b64 v3, v[8:9] offset:40
  s_mov_b64 exec, -1
  s_cmp_eq_u64 vcc, -1
  s_cbranch_scc1 L_att_end
  s_sleep 2
  s_branch L_o_poll
L_att_end:
  s_endpgm
L_att_slow:
  v_mov_b32 v120, 0xff800000
  s_mov_b32 s11, s10
  s_mov_b32 s14, 64
L_att_slow1:
  buffer_load_dwordx4 v[24:27], v2, s[48:51], s11 offen sc1
  s_add_u32 s11, s11, 2048
  s_waitcnt vmcnt(0)
  v_mfma_f32_32x32x16_bf16 v[48:63], v[24:27], v[20:23], 0
  s_nop 11
  v_max3_f32 v120, v48, v49, v120
  v_max3_f32 v120, v50, v51, v120
  v_max3_f32 v120, v52, v53, v120
  v_max3_f32 v120, v54, v55, v120
  v_max3_f32 v120, v56, v57, v120
  v_max3_f32 v120, v58, v59, v120
  v_max3_f32 v120, v60, v61, v120
  v_max3_f32 v120, v62, v63, v120
  s_sub_u32 s14, s14, 1
  s_cmp_lg_u32 s14, 0
  s_cbranch_scc1 L_att_slow1
  v_mov_b32 v121, v120
  s_nop 1
  v_permlane32_swap_b32 v120, v121
  v_max_f32 v120, v120, v121
  v_sub_f32 v88, 0, v120
  v_mov_b32 v136, 0
  v_sub_f32 v89, 0, v120
  v_mov_b32 v137, 0
  v_sub_f32 v90, 0, v120
  v_mov_b32 v138, 0
  v_sub_f32 v91, 0, v120
  v_mov_b32 v139, 0
  v_sub_f32 v92, 0, v120
  v_mov_b32 v140, 0
  v_sub_f32 v93, 0, v120
  v_mov_b32 v141, 0
  v_sub_f32 v94, 0, v120
  v_mov_b32 v142, 0
  v_sub_f32 v95, 0, v120
  v_mov_b32 v143, 0
  v_sub_f32 v96, 0, v120
  v_mov_b32 v144, 0
  v_sub_f32 v97, 0, v120
  v_mov_b32 v145, 0
  v_sub_f32 v98, 0, v120
  v_mov_b32 v146, 0
  v_sub_f32 v99, 0, v120
  v_mov_b32 v147, 0
  v_sub_f32 v100, 0, v120
  v_mov_b32 v148, 0
  v_sub_f32 v101, 0, v120
  v_mov_b32 v149, 0
  v_sub_f32 v102, 0, v120
  v_mov_b32 v150, 0
  v_sub_f32 v103, 0, v120
  v_mov_b32 v151, 0
  s_mov_b32 s11, s10
  s_mov_b32 s14, 64
L_att_slow2:
  buffer_load_dwordx4 v[24:27], v2, s[48:51], s11 offen sc1
  s_mov_b64 exec, s[12:13]
  buffer_load_dwordx4 v[32:35], v4, s[48:51], s11 offen offset:1024 sc1
  buffer_load_dwordx4 v[36:39], v4, s[48:51], s11 offen offset:1536 sc1
  s_mov_b64 exec, -1
  s_add_u32 s11, s11, 2048
  s_waitcnt vmcnt(0)
  v_mfma_f32_32x32x16_bf16 v[48:63], v[24:27], v[20:23], v[88:103]
  s_nop 11
  v_exp_f32 v48, v48
  v_exp_f32 v49, v49
  v_exp_f32 v50, v50
  v_exp_f32 v51, v51
  v_exp_f32 v52, v52
  v_exp_f32 v53, v53
  v_exp_f32 v54, v54
  v_exp_f32 v55, v55
  v_exp_f32 v56, v56
  v_exp_f32 v57, v57
  v_exp_f32 v58, v58
  v_exp_f32 v59, v59
  v_exp_f32 v60, v60
  v_exp_f32 v61, v61
  v_exp_f32 v62, v62
  v_exp_f32 v63, v63
  v_cvt_pk_bf16_f32 v80, v48, v49
  v_cvt_pk_bf16_f32 v81, v50, v51
  v_cvt_pk_bf16_f32 v82, v52, v53
  v_cvt_pk_bf16_f32 v83, v54, v55
  v_cvt_pk_bf16_f32 v84, v56, v57
  v_cvt_pk_bf16_f32 v85, v58, v59
  v_cvt_pk_bf16_f32 v86, v60, v61
  v_cvt_pk_bf16_f32 v87, v62, v63
  v_mfma_f32_32x32x16_bf16 v[136:151], v[32:35], v[80:83], v[136:151]
  s_nop 0
  v_mfma_f32_32x32x16_bf16 v[136:151], v[36:39], v[84:87], v[136:151]
  s_sub_u32 s14, s14, 1
  s_cmp_lg_u32 s14, 0
  s_cbranch_scc1 L_att_slow2
  s_nop 8
  v_rcp_f32 v120, v144
  s_nop 0
  v_mul_f32 v104, v136, v120
  v_mul_f32 v105, v137, v120
  v_mul_f32 v106, v138, v120
  v_mul_f32 v107, v139, v120
  v_mul_f32 v108, v140, v120
  v_mul_f32 v109, v141, v120
  v_mul_f32 v110, v142, v120
  v_mul_f32 v111, v143, v120
  v_cvt_pk_bf16_f32 v80, v104, v105
  v_cvt_pk_bf16_f32 v81, v106, v107
  v_cvt_pk_bf16_f32 v82, v108, v109
  v_cvt_pk_bf16_f32 v83, v110, v111
  buffer_store_dwordx4 v[80:83], v2, s[48:51], s98 offen sc1
  s_branch L_att_fin
L_ffn:
  s_setprio 2
  s_sub_u32 s4, s53, 8
  v_lshlrev_b32 v2, 4, v1
  v_lshrrev_b32 v4, 3, v1
  s_cmp_eq_u32 s96, 7
  s_cbranch_scc1 L_ffn_skip
  v_mul_u32_u24 v9, 3584, v4
  s_lshl_b32 s58, s96, 9
  s_lshl_b32 s59, s4, 7
  s_add_u32 s58, s58, s59
  v_add3_u32 v9, v9, v8, s58
  v_add_u32 v10, 27648, v9
  s_mul_i32 s5, s4, 12288
  s_add_u32 s5, s5, 102400
  s_lshl_b32 s6, s96, 18
  s_mov_b32 s62, 0x55555555
  s_mov_b32 s63, 0x55555555
  s_waitcnt vmcnt(0)
  v_mov_b32 v6, 1
  s_mov_b64 exec, 1
  ds_add_rtn_u32 v5, v3, v6 offset:16
  s_mov_b64 exec, -1
  s_waitcnt lgkmcnt(0)
  v_readfirstlane_b32 s60, v5
  s_nop 0
  s_cmp_eq_u32 s60, 3
  s_cbranch_scc0 recurrent_scan__softmax_full_mha__dense_activation_relu__prompt_kernel_nf9
  v_mov_b32 v5, s52
  v_mov_b32 v6, 0
  s_mov_b64 exec, 1
  buffer_store_dword v5, v6, s[48:51], s23 offen sc1
  s_mov_b64 exec, -1
recurrent_scan__softmax_full_mha__dense_activation_relu__prompt_kernel_nf9:
  s_add_u32 m0, s5, 0
  s_mov_b32 s7, 0
  buffer_load_dwordx4 v9, s[36:39], s7 offen lds
  buffer_load_dwordx4 v10, s[36:39], s7 offen offset:1024 lds
  s_add_u32 m0, s5, 2048
  s_mov_b32 s7, 57344
  buffer_load_dwordx4 v9, s[36:39], s7 offen lds
  buffer_load_dwordx4 v10, s[36:39], s7 offen offset:1024 lds
  s_add_u32 m0, s5, 4096
  s_mov_b32 s7, 114688
  buffer_load_dwordx4 v9, s[36:39], s7 offen lds
  buffer_load_dwordx4 v10, s[36:39], s7 offen offset:1024 lds
  s_add_u32 m0, s5, 6144
  s_mov_b32 s7, 172032
  buffer_load_dwordx4 v9, s[36:39], s7 offen lds
  buffer_load_dwordx4 v10, s[36:39], s7 offen offset:1024 lds
  s_add_u32 m0, s5, 8192
  s_mov_b32 s7, 229376
  buffer_load_dwordx4 v9, s[36:39], s7 offen lds
  buffer_load_dwordx4 v10, s[36:39], s7 offen offset:1024 lds
  s_add_u32 m0, s5, 10240
  s_mov_b32 s7, 286720
  buffer_load_dwordx4 v9, s[36:39], s7 offen lds
  buffer_load_dwordx4 v10, s[36:39], s7 offen offset:1024 lds
  v_lshl_add_u32 v11, v4, 10, v8
  s_lshl_b32 s58, s4, 8
  v_add_u32 v11, s58, v11
  v_add_u32 v12, 7168, v11
  v_and_b32 v4, 15, v1
  v_lshrrev_b32 v5, 2, v4
  v_lshlrev_b32 v5, 7, v5
  v_lshrrev_b32 v6, 3, v4
  v_lshl_add_u32 v5, v6, 6, v5
  v_and_b32 v6, 3, v4
  v_lshl_add_u32 v5, v6, 3, v5
  v_bfe_u32 v6, v1, 4, 1
  v_lshl_add_u32 v5, v6, 5, v5
  v_lshrrev_b32 v6, 5, v1
  v_add_u32 v5, s5, v5
  v_lshl_add_u32 v13, v6, 10, v5
  v_lshl_add_u32 v15, v6, 9, v5
  v_xor_b32 v14, 64, v13
  v_xor_b32 v16, 64, v15
  v_add_u32 v17, 65536, v2
  v_and_b32 v4, 31, v1
  v_lshlrev_b32 v5, 9, v6
  v_xor_b32 v7, 0, v6
  v_xor_b32 v7, v7, v4
  v_lshl_add_u32 v18, v7, 4, v5
  v_xor_b32 v7, 2, v6
  v_xor_b32 v7, v7, v4
  v_lshl_add_u32 v19, v7, 4, v5
  v_xor_b32 v7, 4, v6
  v_xor_b32 v7, v7, v4
  v_lshl_add_u32 v20, v7, 4, v5
  v_xor_b32 v7, 6, v6
  v_xor_b32 v7, v7, v4
  v_lshl_add_u32 v21, v7, 4, v5
  s_lshl_b32 s58, s4, 2
  v_add_u32 v22, s58, v3
  s_waitcnt vmcnt(10)
  ds_read_b128 v[24:27], v18 offset:0
  ds_read_b128 v[28:31], v18 offset:32768
  ds_read_b64_tr_b16 v[40:41], v13 offset:0
  ds_read_b64_tr_b16 v[42:43], v13 offset:512
  ds_read_b64_tr_b16 v[44:45], v14 offset:0
  ds_read_b64_tr_b16 v[46:47], v14 offset:512
  s_setprio 0
  s_waitcnt vmcnt(8) lgkmcnt(0)
  v_mfma_f32_32x32x16_bf16 v[56:71], v[40:43], v[24:27], 0
  ds_read_b128 v[32:35], v19 offset:1024
  ds_read_b128 v[36:39], v19 offset:33792
  v_mfma_f32_32x32x16_bf16 v[72:87], v[44:47], v[24:27], 0
  ds_read_b64_tr_b16 v[48:49], v13 offset:2048
  ds_read_b64_tr_b16 v[50:51], v13 offset:2560
  v_mfma_f32_32x32x16_bf16 v[88:103], v[40:43], v[28:31], 0
  ds_read_b64_tr_b16 v[52:53], v14 offset:2048
  ds_read_b64_tr_b16 v[54:55], v14 offset:2560
  v_mfma_f32_32x32x16_bf16 v[104:119], v[44:47], v[28:31], 0
  s_add_u32 m0, s5, 0
  s_mov_b32 s7, 344064
  buffer_load_dwordx4 v9, s[36:39], s7 offen lds
  buffer_load_dwordx4 v10, s[36:39], s7 offen offset:1024 lds
  s_waitcnt vmcnt(8) lgkmcnt(0)
  v_mfma_f32_32x32x16_bf16 v[56:71], v[48:51], v[32:35], v[56:71]
  ds_read_b128 v[24:27], v20 offset:2048
  ds_read_b128 v[28:31], v20 offset:34816
  v_mfma_f32_32x32x16_bf16 v[72:87], v[52:55], v[32:35], v[72:87]
  ds_read_b64_tr_b16 v[40:41], v13 offset:4096
  ds_read_b64_tr_b16 v[42:43], v13 offset:4608
  v_mfma_f32_32x32x16_bf16 v[88:103], v[48:51], v[36:39], v[88:103]
  ds_read_b64_tr_b16 v[44:45], v14 offset:4096
  ds_read_b64_tr_b16 v[46:47], v14 offset:4608
  v_mfma_f32_32x32x16_bf16 v[104:119], v[52:55], v[36:39], v[104:119]
  s_add_u32 m0, s5, 2048
  s_mov_b32 s7, 401408
  buffer_load_dwordx4 v9, s[36:39], s7 offen lds
  buffer_load_dwordx4 v10, s[36:39], s7 offen offset:1024 lds
  s_waitcnt vmcnt(8) lgkmcnt(0)
  v_mfma_f32_32x32x16_bf16 v[56:71], v[40:43], v[24:27], v[56:71]
  ds_read_b128 v[32:35], v21 offset:3072
  ds_read_b128 v[36:39], v21 offset:35840
  v_mfma_f32_32x32x16_bf16 v[72:87], v[44:47], v[24:27], v[72:87]
  ds_read_b64_tr_b16 v[48:49], v13 offset:6144
  ds_read_b64_tr_b16 v[50:51], v13 offset:6656
  v_mfma_f32_32x32x16_bf16 v[88:103], v[40:43], v[28:31], v[88:103]
  ds_read_b64_tr_b16 v[52:53], v14 offset:6144
  ds_read_b64_tr_b16 v[54:55], v14 offset:6656
  v_mfma_f32_32x32x16_bf16 v[104:119], v[44:47], v[28:31], v[104:119]
  s_add_u32 m0, s5, 4096
  s_mov_b32 s7, 458752
  buffer_load_dwordx4 v9, s[36:39], s7 offen lds
  buffer_load_dwordx4 v10, s[36:39], s7 offen offset:1024 lds
  s_waitcnt vmcnt(8) lgkmcnt(0)
  v_mfma_f32_32x32x16_bf16 v[56:71], v[48:51], v[32:35], v[56:71]
  ds_read_b128 v[24:27], v18 offset:4096
  ds_read_b128 v[28:31], v18 offset:36864
  v_mfma_f32_32x32x16_bf16 v[72:87], v[52:55], v[32:35], v[72:87]
  ds_read_b64_tr_b16 v[40:41], v13 offset:8192
  ds_read_b64_tr_b16 v[42:43], v13 offset:8704
  v_mfma_f32_32x32x16_bf16 v[88:103], v[48:51], v[36:39], v[88:103]
  ds_read_b64_tr_b16 v[44:45], v14 offset:8192
  ds_read_b64_tr_b16 v[46:47], v14 offset:8704
  v_mfma_f32_32x32x16_bf16 v[104:119], v[52:55], v[36:39], v[104:119]
  s_add_u32 m0, s5, 6144
  s_mov_b32 s7, 516096
  buffer_load_dwordx4 v9, s[36:39], s7 offen lds
  buffer_load_dwordx4 v10, s[36:39], s7 offen offset:1024 lds
  s_waitcnt vmcnt(8) lgkmcnt(0)
  v_mfma_f32_32x32x16_bf16 v[56:71], v[40:43], v[24:27], v[56:71]
  ds_read_b128 v[32:35], v19 offset:5120
  ds_read_b128 v[36:39], v19 offset:37888
  v_mfma_f32_32x32x16_bf16 v[72:87], v[44:47], v[24:27], v[72:87]
  ds_read_b64_tr_b16 v[48:49], v13 offset:10240
  ds_read_b64_tr_b16 v[50:51], v13 offset:10752
  v_mfma_f32_32x32x16_bf16 v[88:103], v[40:43], v[28:31], v[88:103]
  ds_read_b64_tr_b16 v[52:53], v14 offset:10240
  ds_read_b64_tr_b16 v[54:55], v14 offset:10752
  v_mfma_f32_32x32x16_bf16 v[104:119], v[44:47], v[28:31], v[104:119]
  s_add_u32 m0, s5, 8192
  s_mov_b32 s7, 573440
  buffer_load_dwordx4 v9, s[36:39], s7 offen lds
  buffer_load_dwordx4 v10, s[36:39], s7 offen offset:1024 lds
  s_waitcnt vmcnt(8) lgkmcnt(0)
  v_mfma_f32_32x32x16_bf16 v[56:71], v[48:51], v[32:35], v[56:71]
  ds_read_b128 v[24:27], v20 offset:6144
  ds_read_b128 v[28:31], v20 offset:38912
  v_mfma_f32_32x32x16_bf16 v[72:87], v[52:55], v[32:35], v[72:87]
  ds_read_b64_tr_b16 v[40:41], v13 offset:0
  ds_read_b64_tr_b16 v[42:43], v13 offset:512
  v_mfma_f32_32x32x16_bf16 v[88:103], v[48:51], v[36:39], v[88:103]
  ds_read_b64_tr_b16 v[44:45], v14 offset:0
  ds_read_b64_tr_b16 v[46:47], v14 offset:512
  v_mfma_f32_32x32x16_bf16 v[104:119], v[52:55], v[36:39], v[104:119]
  s_add_u32 m0, s5, 10240
  s_mov_b32 s7, 630784
  buffer_load_dwordx4 v9, s[36:39], s7 offen lds
  buffer_load_dwordx4 v10, s[36:39], s7 offen offset:1024 lds
  s_waitcnt vmcnt(8) lgkmcnt(0)
  v_mfma_f32_32x32x16_bf16 v[56:71], v[40:43], v[24:27], v[56:71]
  ds_read_b128 v[32:35], v21 offset:7168
  ds_read_b128 v[36:39], v21 offset:39936
  v_mfma_f32_32x32x16_bf16 v[72:87], v[44:47], v[24:27], v[72:87]
  ds_read_b64_tr_b16 v[48:49], v13 offset:2048
  ds_read_b64_tr_b16 v[50:51], v13 offset:2560
  v_mfma_f32_32x32x16_bf16 v[88:103], v[40:43], v[28:31], v[88:103]
  ds_read_b64_tr_b16 v[52:53], v14 offset:2048
  ds_read_b64_tr_b16 v[54:55], v14 offset:2560
  v_mfma_f32_32x32x16_bf16 v[104:119], v[44:47], v[28:31], v[104:119]
  s_add_u32 m0, s5, 0
  s_mov_b32 s7, 688128
  buffer_load_dwordx4 v9, s[36:39], s7 offen lds
  buffer_load_dwordx4 v10, s[36:39], s7 offen offset:1024 lds
  s_waitcnt vmcnt(8) lgkmcnt(0)
  v_mfma_f32_32x32x16_bf16 v[56:71], v[48:51], v[32:35], v[56:71]
  ds_read_b128 v[24:27], v18 offset:8192
  ds_read_b128 v[28:31], v18 offset:40960
  v_mfma_f32_32x32x16_bf16 v[72:87], v[52:55], v[32:35], v[72:87]
  ds_read_b64_tr_b16 v[40:41], v13 offset:4096
  ds_read_b64_tr_b16 v[42:43], v13 offset:4608
  v_mfma_f32_32x32x16_bf16 v[88:103], v[48:51], v[36:39], v[88:103]
  ds_read_b64_tr_b16 v[44:45], v14 offset:4096
  ds_read_b64_tr_b16 v[46:47], v14 offset:4608
  v_mfma_f32_32x32x16_bf16 v[104:119], v[52:55], v[36:39], v[104:119]
  s_add_u32 m0, s5, 2048
  s_mov_b32 s7, 745472
  buffer_load_dwordx4 v9, s[36:39], s7 offen lds
  buffer_load_dwordx4 v10, s[36:39], s7 offen offset:1024 lds
  s_waitcnt vmcnt(8) lgkmcnt(0)
  v_mfma_f32_32x32x16_bf16 v[56:71], v[40:43], v[24:27], v[56:71]
  ds_read_b128 v[32:35], v19 offset:9216
  ds_read_b128 v[36:39], v19 offset:41984
  v_mfma_f32_32x32x16_bf16 v[72:87], v[44:47], v[24:27], v[72:87]
  ds_read_b64_tr_b16 v[48:49], v13 offset:6144
  ds_read_b64_tr_b16 v[50:51], v13 offset:6656
  v_mfma_f32_32x32x16_bf16 v[88:103], v[40:43], v[28:31], v[88:103]
  ds_read_b64_tr_b16 v[52:53], v14 offset:6144
  ds_read_b64_tr_b16 v[54:55], v14 offset:6656
  v_mfma_f32_32x32x16_bf16 v[104:119], v[44:47], v[28:31], v[104:119]
  s_add_u32 m0, s5, 4096
  s_mov_b32 s7, 802816
  buffer_load_dwordx4 v9, s[36:39], s7 offen lds
  buffer_load_dwordx4 v10, s[36:39], s7 offen offset:1024 lds
  s_waitcnt vmcnt(8) lgkmcnt(0)
  v_mfma_f32_32x32x16_bf16 v[56:71], v[48:51], v[32:35], v[56:71]
  ds_read_b128 v[24:27], v20 offset:10240
  ds_read_b128 v[28:31], v20 offset:43008
  v_mfma_f32_32x32x16_bf16 v[72:87], v[52:55], v[32:35], v[72:87]
  ds_read_b64_tr_b16 v[40:41], v13 offset:8192
  ds_read_b64_tr_b16 v[42:43], v13 offset:8704
  v_mfma_f32_32x32x16_bf16 v[88:103], v[48:51], v[36:39], v[88:103]
  ds_read_b64_tr_b16 v[44:45], v14 offset:8192
  ds_read_b64_tr_b16 v[46:47], v14 offset:8704
  v_mfma_f32_32x32x16_bf16 v[104:119], v[52:55], v[36:39], v[104:119]
  s_add_u32 m0, s5, 6144
  s_mov_b32 s7, 860160
  buffer_load_dwordx4 v9, s[36:39], s7 offen lds
  buffer_load_dwordx4 v10, s[36:39], s7 offen offset:1024 lds
  s_waitcnt vmcnt(8) lgkmcnt(0)
  v_mfma_f32_32x32x16_bf16 v[56:71], v[40:43], v[24:27], v[56:71]
  ds_read_b128 v[32:35], v21 offset:11264
  ds_read_b128 v[36:39], v21 offset:44032
  v_mfma_f32_32x32x16_bf16 v[72:87], v[44:47], v[24:27], v[72:87]
  ds_read_b64_tr_b16 v[48:49], v13 offset:10240
  ds_read_b64_tr_b16 v[50:51], v13 offset:10752
  v_mfma_f32_32x32x16_bf16 v[88:103], v[40:43], v[28:31], v[88:103]
  ds_read_b64_tr_b16 v[52:53], v14 offset:10240
  ds_read_b64_tr_b16 v[54:55], v14 offset:10752
  v_mfma_f32_32x32x16_bf16 v[104:119], v[44:47], v[28:31], v[104:119]
  s_add_u32 m0, s5, 8192
  s_mov_b32 s7, 917504
  buffer_load_dwordx4 v9, s[36:39], s7 offen lds
  buffer_load_dwordx4 v10, s[36:39], s7 offen offset:1024 lds
  s_waitcnt vmcnt(8) lgkmcnt(0)
  v_mfma_f32_32x32x16_bf16 v[56:71], v[48:51], v[32:35], v[56:71]
  ds_read_b128 v[24:27], v18 offset:12288
  ds_read_b128 v[28:31], v18 offset:45056
  v_mfma_f32_32x32x16_bf16 v[72:87], v[52:55], v[32:35], v[72:87]
  ds_read_b64_tr_b16 v[40:41], v13 offset:0
  ds_read_b64_tr_b16 v[42:43], v13 offset:512
  v_mfma_f32_32x32x16_bf16 v[88:103], v[48:51], v[36:39], v[88:103]
  ds_read_b64_tr_b16 v[44:45], v14 offset:0
  ds_read_b64_tr_b16 v[46:47], v14 offset:512
  v_mfma_f32_32x32x16_bf16 v[104:119], v[52:55], v[36:39], v[104:119]
  s_add_u32 m0, s5, 10240
  s_mov_b32 s7, 974848
  buffer_load_dwordx4 v9, s[36:39], s7 offen lds
  buffer_load_dwordx4 v10, s[36:39], s7 offen offset:1024 lds
  s_waitcnt vmcnt(8) lgkmcnt(0)
  v_mfma_f32_32x32x16_bf16 v[56:71], v[40:43], v[24:27], v[56:71]
  ds_read_b128 v[32:35], v19 offset:13312
  ds_read_b128 v[36:39], v19 offset:46080
  v_mfma_f32_32x32x16_bf16 v[72:87], v[44:47], v[24:27], v[72:87]
  ds_read_b64_tr_b16 v[48:49], v13 offset:2048
  ds_read_b64_tr_b16 v[50:51], v13 offset:2560
  v_mfma_f32_32x32x16_bf16 v[88:103], v[40:43], v[28:31], v[88:103]
  ds_read_b64_tr_b16 v[52:53], v14 offset:2048
  ds_read_b64_tr_b16 v[54:55], v14 offset:2560
  v_mfma_f32_32x32x16_bf16 v[104:119], v[44:47], v[28:31], v[104:119]
  s_add_u32 m0, s5, 0
  s_mov_b32 s7, 1032192
  buffer_load_dwordx4 v9, s[36:39], s7 offen lds
  buffer_load_dwordx4 v10, s[36:39], s7 offen offset:1024 lds
  s_waitcnt vmcnt(8) lgkmcnt(0)
  v_mfma_f32_32x32x16_bf16 v[56:71], v[48:51], v[32:35], v[56:71]
  ds_read_b128 v[24:27], v20 offset:14336
  ds_read_b128 v[28:31], v20 offset:47104
  v_mfma_f32_32x32x16_bf16 v[72:87], v[52:55], v[32:35], v[72:87]
  ds_read_b64_tr_b16 v[40:41], v13 offset:4096
  ds_read_b64_tr_b16 v[42:43], v13 offset:4608
  v_mfma_f32_32x32x16_bf16 v[88:103], v[48:51], v[36:39], v[88:103]
  ds_read_b64_tr_b16 v[44:45], v14 offset:4096
  ds_read_b64_tr_b16 v[46:47], v14 offset:4608
  v_mfma_f32_32x32x16_bf16 v[104:119], v[52:55], v[36:39], v[104:119]
  s_add_u32 m0, s5, 2048
  s_mov_b32 s7, 1089536
  buffer_load_dwordx4 v9, s[36:39], s7 offen lds
  buffer_load_dwordx4 v10, s[36:39], s7 offen offset:1024 lds
  s_waitcnt vmcnt(8) lgkmcnt(0)
  v_mfma_f32_32x32x16_bf16 v[56:71], v[40:43], v[24:27], v[56:71]
  ds_read_b128 v[32:35], v21 offset:15360
  ds_read_b128 v[36:39], v21 offset:48128
  v_mfma_f32_32x32x16_bf16 v[72:87], v[44:47], v[24:27], v[72:87]
  ds_read_b64_tr_b16 v[48:49], v13 offset:6144
  ds_read_b64_tr_b16 v[50:51], v13 offset:6656
  v_mfma_f32_32x32x16_bf16 v[88:103], v[40:43], v[28:31], v[88:103]
  ds_read_b64_tr_b16 v[52:53], v14 offset:6144
  ds_read_b64_tr_b16 v[54:55], v14 offset:6656
  v_mfma_f32_32x32x16_bf16 v[104:119], v[44:47], v[28:31], v[104:119]
  s_add_u32 m0, s5, 4096
  s_mov_b32 s7, 1146880
  buffer_load_dwordx4 v9, s[36:39], s7 offen lds
  buffer_load_dwordx4 v10, s[36:39], s7 offen offset:1024 lds
  s_waitcnt vmcnt(8) lgkmcnt(0)
  v_mfma_f32_32x32x16_bf16 v[56:71], v[48:51], v[32:35], v[56:71]
  ds_read_b128 v[24:27], v18 offset:16384
  ds_read_b128 v[28:31], v18 offset:49152
  v_mfma_f32_32x32x16_bf16 v[72:87], v[52:55], v[32:35], v[72:87]
  ds_read_b64_tr_b16 v[40:41], v13 offset:8192
  ds_read_b64_tr_b16 v[42:43], v13 offset:8704
  v_mfma_f32_32x32x16_bf16 v[88:103], v[48:51], v[36:39], v[88:103]
  ds_read_b64_tr_b16 v[44:45], v14 offset:8192
  ds_read_b64_tr_b16 v[46:47], v14 offset:8704
  ds_read_b32 v23, v22 offset:48
  v_mfma_f32_32x32x16_bf16 v[104:119], v[52:55], v[36:39], v[104:119]
  s_add_u32 m0, s5, 6144
  s_mov_b32 s7, 1204224
  buffer_load_dwordx4 v9, s[36:39], s7 offen lds
  buffer_load_dwordx4 v10, s[36:39], s7 offen offset:1024 lds
  s_waitcnt vmcnt(8) lgkmcnt(0)
  s_setprio 3
  v_readfirstlane_b32 s60, v23
  s_setprio 3
  s_cmp_ge_u32 s60, 2
  s_cbranch_scc1 recurrent_scan__softmax_full_mha__dense_activation_relu__prompt_kernel_bo10
  s_setprio 0
recurrent_scan__softmax_full_mha__dense_activation_relu__prompt_kernel_bo10:
  v_mfma_f32_32x32x16_bf16 v[56:71], v[40:43], v[24:27], v[56:71]
  ds_read_b128 v[32:35], v19 offset:17408
  ds_read_b128 v[36:39], v19 offset:50176
  v_mfma_f32_32x32x16_bf16 v[72:87], v[44:47], v[24:27], v[72:87]
  ds_read_b64_tr_b16 v[48:49], v13 offset:10240
  ds_read_b64_tr_b16 v[50:51], v13 offset:10752
  v_mfma_f32_32x32x16_bf16 v[88:103], v[40:43], v[28:31], v[88:103]
  ds_read_b64_tr_b16 v[52:53], v14 offset:10240
  ds_read_b64_tr_b16 v[54:55], v14 offset:10752
  v_mfma_f32_32x32x16_bf16 v[104:119], v[44:47], v[28:31], v[104:119]
  s_add_u32 m0, s5, 8192
  s_mov_b32 s7, 1261568
  buffer_load_dwordx4 v9, s[36:39], s7 offen lds
  buffer_load_dwordx4 v10, s[36:39], s7 offen offset:1024 lds
  s_waitcnt vmcnt(8) lgkmcnt(0)
  v_mfma_f32_32x32x16_bf16 v[56:71], v[48:51], v[32:35], v[56:71]
  ds_read_b128 v[24:27], v20 offset:18432
  ds_read_b128 v[28:31], v20 offset:51200
  v_mfma_f32_32x32x16_bf16 v[72:87], v[52:55], v[32:35], v[72:87]
  ds_read_b64_tr_b16 v[40:41], v13 offset:0
  ds_read_b64_tr_b16 v[42:43], v13 offset:512
  v_mfma_f32_32x32x16_bf16 v[88:103], v[48:51], v[36:39], v[88:103]
  ds_read_b64_tr_b16 v[44:45], v14 offset:0
  ds_read_b64_tr_b16 v[46:47], v14 offset:512
  v_mfma_f32_32x32x16_bf16 v[104:119], v[52:55], v[36:39], v[104:119]
  s_add_u32 m0, s5, 10240
  s_mov_b32 s7, 1318912
  buffer_load_dwordx4 v9, s[36:39], s7 offen lds
  buffer_load_dwordx4 v10, s[36:39], s7 offen offset:1024 lds
  s_waitcnt vmcnt(8) lgkmcnt(0)
  v_mfma_f32_32x32x16_bf16 v[56:71], v[40:43], v[24:27], v[56:71]
  ds_read_b128 v[32:35], v21 offset:19456
  ds_read_b128 v[36:39], v21 offset:52224
  v_mfma_f32_32x32x16_bf16 v[72:87], v[44:47], v[24:27], v[72:87]
  ds_read_b64_tr_b16 v[48:49], v13 offset:2048
  ds_read_b64_tr_b16 v[50:51], v13 offset:2560
  v_mfma_f32_32x32x16_bf16 v[88:103], v[40:43], v[28:31], v[88:103]
  ds_read_b64_tr_b16 v[52:53], v14 offset:2048
  ds_read_b64_tr_b16 v[54:55], v14 offset:2560
  v_mfma_f32_32x32x16_bf16 v[104:119], v[44:47], v[28:31], v[104:119]
  s_add_u32 m0, s5, 0
  s_mov_b32 s7, 1376256
  buffer_load_dwordx4 v9, s[36:39], s7 offen lds
  buffer_load_dwordx4 v10, s[36:39], s7 offen offset:1024 lds
  s_waitcnt vmcnt(8) lgkmcnt(0)
  v_mfma_f32_32x32x16_bf16 v[56:71], v[48:51], v[32:35], v[56:71]
  ds_read_b128 v[24:27], v18 offset:20480
  ds_read_b128 v[28:31], v18 offset:53248
  v_mfma_f32_32x32x16_bf16 v[72:87], v[52:55], v[32:35], v[72:87]
  ds_read_b64_tr_b16 v[40:41], v13 offset:4096
  ds_read_b64_tr_b16 v[42:43], v13 offset:4608
  v_mfma_f32_32x32x16_bf16 v[88:103], v[48:51], v[36:39], v[88:103]
  ds_read_b64_tr_b16 v[44:45], v14 offset:4096
  ds_read_b64_tr_b16 v[46:47], v14 offset:4608
  ds_read_b32 v23, v22 offset:48
  v_mfma_f32_32x32x16_bf16 v[104:119], v[52:55], v[36:39], v[104:119]
  s_add_u32 m0, s5, 2048
  s_mov_b32 s7, 1433600
  buffer_load_dwordx4 v9, s[36:39], s7 offen lds
  buffer_load_dwordx4 v10, s[36:39], s7 offen offset:1024 lds
  s_waitcnt vmcnt(8) lgkmcnt(0)
  s_setprio 3
  v_readfirstlane_b32 s60, v23
  s_setprio 3
  s_cmp_ge_u32 s60, 3
  s_cbranch_scc1 recurrent_scan__softmax_full_mha__dense_activation_relu__prompt_kernel_bo11
  s_setprio 0
recurrent_scan__softmax_full_mha__dense_activation_relu__prompt_kernel_bo11:
  v_mfma_f32_32x32x16_bf16 v[56:71], v[40:43], v[24:27], v[56:71]
  ds_read_b128 v[32:35], v19 offset:21504
  ds_read_b128 v[36:39], v19 offset:54272
  v_mfma_f32_32x32x16_bf16 v[72:87], v[44:47], v[24:27], v[72:87]
  ds_read_b64_tr_b16 v[48:49], v13 offset:6144
  ds_read_b64_tr_b16 v[50:51], v13 offset:6656
  v_mfma_f32_32x32x16_bf16 v[88:103], v[40:43], v[28:31], v[88:103]
  ds_read_b64_tr_b16 v[52:53], v14 offset:6144
  ds_read_b64_tr_b16 v[54:55], v14 offset:6656
  v_mfma_f32_32x32x16_bf16 v[104:119], v[44:47], v[28:31], v[104:119]
  s_add_u32 m0, s5, 4096
  s_mov_b32 s7, 1490944
  buffer_load_dwordx4 v9, s[36:39], s7 offen lds
  buffer_load_dwordx4 v10, s[36:39], s7 offen offset:1024 lds
  s_waitcnt vmcnt(8) lgkmcnt(0)
  v_mfma_f32_32x32x16_bf16 v[56:71], v[48:51], v[32:35], v[56:71]
  ds_read_b128 v[24:27], v20 offset:22528
  ds_read_b128 v[28:31], v20 offset:55296
  v_mfma_f32_32x32x16_bf16 v[72:87], v[52:55], v[32:35], v[72:87]
  ds_read_b64_tr_b16 v[40:41], v13 offset:8192
  ds_read_b64_tr_b16 v[42:43], v13 offset:8704
  v_mfma_f32_32x32x16_bf16 v[88:103], v[48:51], v[36:39], v[88:103]
  ds_read_b64_tr_b16 v[44:45], v14 offset:8192
  ds_read_b64_tr_b16 v[46:47], v14 offset:8704
  v_mfma_f32_32x32x16_bf16 v[104:119], v[52:55], v[36:39], v[104:119]
  s_add_u32 m0, s5, 6144
  s_mov_b32 s7, 1548288
  buffer_load_dwordx4 v9, s[36:39], s7 offen lds
  buffer_load_dwordx4 v10, s[36:39], s7 offen offset:1024 lds
  s_waitcnt vmcnt(8) lgkmcnt(0)
  v_mfma_f32_32x32x16_bf16 v[56:71], v[40:43], v[24:27], v[56:71]
  ds_read_b128 v[32:35], v21 offset:23552
  ds_read_b128 v[36:39], v21 offset:56320
  v_mfma_f32_32x32x16_bf16 v[72:87], v[44:47], v[24:27], v[72:87]
  ds_read_b64_tr_b16 v[48:49], v13 offset:10240
  ds_read_b64_tr_b16 v[50:51], v13 offset:10752
  v_mfma_f32_32x32x16_bf16 v[88:103], v[40:43], v[28:31], v[88:103]
  ds_read_b64_tr_b16 v[52:53], v14 offset:10240
  ds_read_b64_tr_b16 v[54:55], v14 offset:10752
  v_mfma_f32_32x32x16_bf16 v[104:119], v[44:47], v[28:31], v[104:119]
  s_add_u32 m0, s5, 8192
  s_mov_b32 s7, 1605632
  buffer_load_dwordx4 v9, s[36:39], s7 offen lds
  buffer_load_dwordx4 v10, s[36:39], s7 offen offset:1024 lds
  s_waitcnt vmcnt(8) lgkmcnt(0)
  v_mfma_f32_32x32x16_bf16 v[56:71], v[48:51], v[32:35], v[56:71]
  ds_read_b128 v[24:27], v18 offset:24576
  ds_read_b128 v[28:31], v18 offset:57344
  v_mfma_f32_32x32x16_bf16 v[72:87], v[52:55], v[32:35], v[72:87]
  ds_read_b64_tr_b16 v[40:41], v13 offset:0
  ds_read_b64_tr_b16 v[42:43], v13 offset:512
  v_mfma_f32_32x32x16_bf16 v[88:103], v[48:51], v[36:39], v[88:103]
  ds_read_b64_tr_b16 v[44:45], v14 offset:0
  ds_read_b64_tr_b16 v[46:47], v14 offset:512
  ds_read_b32 v23, v22 offset:48
  v_mfma_f32_32x32x16_bf16 v[104:119], v[52:55], v[36:39], v[104:119]
  s_add_u32 m0, s5, 10240
  s_mov_b32 s7, 1662976
  buffer_load_dwordx4 v9, s[36:39], s7 offen lds
  buffer_load_dwordx4 v10, s[36:39], s7 offen offset:1024 lds
  s_waitcnt vmcnt(8) lgkmcnt(0)
  s_setprio 3
  v_readfirstlane_b32 s60, v23
  s_setprio 3
  s_cmp_ge_u32 s60, 4
  s_cbranch_scc1 recurrent_scan__softmax_full_mha__dense_activation_relu__prompt_kernel_bo12
  s_setprio 0
recurrent_scan__softmax_full_mha__dense_activation_relu__prompt_kernel_bo12:
  v_mfma_f32_32x32x16_bf16 v[56:71], v[40:43], v[24:27], v[56:71]
  ds_read_b128 v[32:35], v19 offset:25600
  ds_read_b128 v[36:39], v19 offset:58368
  v_mfma_f32_32x32x16_bf16 v[72:87], v[44:47], v[24:27], v[72:87]
  ds_read_b64_tr_b16 v[48:49], v13 offset:2048
  ds_read_b64_tr_b16 v[50:51], v13 offset:2560
  v_mfma_f32_32x32x16_bf16 v[88:103], v[40:43], v[28:31], v[88:103]
  ds_read_b64_tr_b16 v[52:53], v14 offset:2048
  ds_read_b64_tr_b16 v[54:55], v14 offset:2560
  v_mfma_f32_32x32x16_bf16 v[104:119], v[44:47], v[28:31], v[104:119]
  s_add_u32 m0, s5, 0
  s_mov_b32 s7, 1720320
  buffer_load_dwordx4 v9, s[36:39], s7 offen lds
  buffer_load_dwordx4 v10, s[36:39], s7 offen offset:1024 lds
  s_waitcnt vmcnt(8) lgkmcnt(0)
  v_mfma_f32_32x32x16_bf16 v[56:71], v[48:51], v[32:35], v[56:71]
  ds_read_b128 v[24:27], v20 offset:26624
  ds_read_b128 v[28:31], v20 offset:59392
  v_mfma_f32_32x32x16_bf16 v[72:87], v[52:55], v[32:35], v[72:87]
  ds_read_b64_tr_b16 v[40:41], v13 offset:4096
  ds_read_b64_tr_b16 v[42:43], v13 offset:4608
  v_mfma_f32_32x32x16_bf16 v[88:103], v[48:51], v[36:39], v[88:103]
  ds_read_b64_tr_b16 v[44:45], v14 offset:4096
  ds_read_b64_tr_b16 v[46:47], v14 offset:4608
  v_mfma_f32_32x32x16_bf16 v[104:119], v[52:55], v[36:39], v[104:119]
  s_add_u32 m0, s5, 2048
  s_mov_b32 s7, 1777664
  buffer_load_dwordx4 v9, s[36:39], s7 offen lds
  buffer_load_dwordx4 v10, s[36:39], s7 offen offset:1024 lds
  s_waitcnt vmcnt(8) lgkmcnt(0)
  v_mfma_f32_32x32x16_bf16 v[56:71], v[40:43], v[24:27], v[56:71]
  ds_read_b128 v[32:35], v21 offset:27648
  ds_read_b128 v[36:39], v21 offset:60416
  v_mfma_f32_32x32x16_bf16 v[72:87], v[44:47], v[24:27], v[72:87]
  ds_read_b64_tr_b16 v[48:49], v13 offset:6144
  ds_read_b64_tr_b16 v[50:51], v13 offset:6656
  v_mfma_f32_32x32x16_bf16 v[88:103], v[40:43], v[28:31], v[88:103]
  ds_read_b64_tr_b16 v[52:53], v14 offset:6144
  ds_read_b64_tr_b16 v[54:55], v14 offset:6656
  v_mfma_f32_32x32x16_bf16 v[104:119], v[44:47], v[28:31], v[104:119]
  s_add_u32 m0, s5, 4096
  s_add_u32 s7, s6, 0
  buffer_load_dwordx4 v11, s[40:43], s7 offen lds
  buffer_load_dwordx4 v12, s[40:43], s7 offen offset:1024 lds
  s_waitcnt vmcnt(8) lgkmcnt(0)
  v_mfma_f32_32x32x16_bf16 v[56:71], v[48:51], v[32:35], v[56:71]
  ds_read_b128 v[24:27], v18 offset:28672
  ds_read_b128 v[28:31], v18 offset:61440
  v_mfma_f32_32x32x16_bf16 v[72:87], v[52:55], v[32:35], v[72:87]
  ds_read_b64_tr_b16 v[40:41], v13 offset:8192
  ds_read_b64_tr_b16 v[42:43], v13 offset:8704
  v_mfma_f32_32x32x16_bf16 v[88:103], v[48:51], v[36:39], v[88:103]
  ds_read_b64_tr_b16 v[44:45], v14 offset:8192
  ds_read_b64_tr_b16 v[46:47], v14 offset:8704
  ds_read_b32 v23, v22 offset:48
  v_mfma_f32_32x32x16_bf16 v[104:119], v[52:55], v[36:39], v[104:119]
  s_add_u32 m0, s5, 6144
  s_add_u32 s7, s6, 16384
  buffer_load_dwordx4 v11, s[40:43], s7 offen lds
  buffer_load_dwordx4 v12, s[40:43], s7 offen offset:1024 lds
  s_waitcnt vmcnt(8) lgkmcnt(0)
  s_lshl_b32 s58, s57, 2
  s_add_u32 s58, s58, s4
  s_mul_i32 s58, s58, 6144
  s_lshl_b32 s59, s97, 18
  s_add_u32 s58, s58, s59
  v_lshlrev_b32 v4, 7, v1
  s_mov_b32 exec_lo, -1
  s_mov_b32 exec_hi, 0xffff
  buffer_load_dword v163, v4, s[40:43], s58 offen
  s_mov_b64 exec, -1
  s_setprio 3
  v_readfirstlane_b32 s60, v23
  s_setprio 3
  s_cmp_ge_u32 s60, 5
  s_cbranch_scc1 recurrent_scan__softmax_full_mha__dense_activation_relu__prompt_kernel_bo13
  s_setprio 0
recurrent_scan__softmax_full_mha__dense_activation_relu__prompt_kernel_bo13:
  v_mfma_f32_32x32x16_bf16 v[56:71], v[40:43], v[24:27], v[56:71]
  ds_read_b128 v[32:35], v19 offset:29696
  ds_read_b128 v[36:39], v19 offset:62464
  v_mfma_f32_32x32x16_bf16 v[72:87], v[44:47], v[24:27], v[72:87]
  ds_read_b64_tr_b16 v[48:49], v13 offset:10240
  ds_read_b64_tr_b16 v[50:51], v13 offset:10752
  v_mfma_f32_32x32x16_bf16 v[88:103], v[40:43], v[28:31], v[88:103]
  ds_read_b64_tr_b16 v[52:53], v14 offset:10240
  ds_read_b64_tr_b16 v[54:55], v14 offset:10752
  v_mfma_f32_32x32x16_bf16 v[104:119], v[44:47], v[28:31], v[104:119]
  s_add_u32 m0, s5, 8192
  s_add_u32 s7, s6, 32768
  buffer_load_dwordx4 v11, s[40:43], s7 offen lds
  buffer_load_dwordx4 v12, s[40:43], s7 offen offset:1024 lds
  s_waitcnt vmcnt(9) lgkmcnt(0)
  v_mfma_f32_32x32x16_bf16 v[56:71], v[48:51], v[32:35], v[56:71]
  ds_read_b128 v[24:27], v20 offset:30720
  ds_read_b128 v[28:31], v20 offset:63488
  v_mfma_f32_32x32x16_bf16 v[72:87], v[52:55], v[32:35], v[72:87]
  ds_read_b64_tr_b16 v[40:41], v13 offset:0
  ds_read_b64_tr_b16 v[42:43], v13 offset:512
  v_mfma_f32_32x32x16_bf16 v[88:103], v[48:51], v[36:39], v[88:103]
  ds_read_b64_tr_b16 v[44:45], v14 offset:0
  ds_read_b64_tr_b16 v[46:47], v14 offset:512
  v_mfma_f32_32x32x16_bf16 v[104:119], v[52:55], v[36:39], v[104:119]
  s_add_u32 m0, s5, 10240
  s_add_u32 s7, s6, 49152
  buffer_load_dwordx4 v11, s[40:43], s7 offen lds
  buffer_load_dwordx4 v12, s[40:43], s7 offen offset:1024 lds
  s_waitcnt vmcnt(9) lgkmcnt(0)
  v_mfma_f32_32x32x16_bf16 v[56:71], v[40:43], v[24:27], v[56:71]
  ds_read_b128 v[32:35], v21 offset:31744
  ds_read_b128 v[36:39], v21 offset:64512
  v_mfma_f32_32x32x16_bf16 v[72:87], v[44:47], v[24:27], v[72:87]
  ds_read_b64_tr_b16 v[48:49], v13 offset:2048
  ds_read_b64_tr_b16 v[50:51], v13 offset:2560
  v_mfma_f32_32x32x16_bf16 v[88:103], v[40:43], v[28:31], v[88:103]
  ds_read_b64_tr_b16 v[52:53], v14 offset:2048
  ds_read_b64_tr_b16 v[54:55], v14 offset:2560
  v_mfma_f32_32x32x16_bf16 v[104:119], v[44:47], v[28:31], v[104:119]
  s_add_u32 m0, s5, 0
  s_add_u32 s7, s6, 65536
  buffer_load_dwordx4 v11, s[40:43], s7 offen lds
  buffer_load_dwordx4 v12, s[40:43], s7 offen offset:1024 lds
  s_waitcnt lgkmcnt(0)
  v_mfma_f32_32x32x16_bf16 v[56:71], v[48:51], v[32:35], v[56:71]
  v_mfma_f32_32x32x16_bf16 v[72:87], v[52:55], v[32:35], v[72:87]
  v_mfma_f32_32x32x16_bf16 v[88:103], v[48:51], v[36:39], v[88:103]
  v_mfma_f32_32x32x16_bf16 v[104:119], v[52:55], v[36:39], v[104:119]
  s_add_u32 m0, s5, 2048
  s_add_u32 s7, s6, 81920
  buffer_load_dwordx4 v11, s[40:43], s7 offen lds
  buffer_load_dwordx4 v12, s[40:43], s7 offen offset:1024 lds
  s_setprio 2
  s_mov_b32 s61, 524288
recurrent_scan__softmax_full_mha__dense_activation_relu__prompt_kernel_wq14:
  ds_read_b32 v4, v3 offset:0
  s_waitcnt lgkmcnt(0)
  v_readfirstlane_b32 s60, v4
  s_sub_u32 s61, s61, 1
  s_cbranch_scc1 recurrent_scan__softmax_full_mha__dense_activation_relu__prompt_kernel_wqd15
  s_cmp_ge_u32 s60, 4
  s_cbranch_scc1 recurrent_scan__softmax_full_mha__dense_activation_relu__prompt_kernel_wqd15
  s_sleep 2
  s_branch recurrent_scan__softmax_full_mha__dense_activation_relu__prompt_kernel_wq14
recurrent_scan__softmax_full_mha__dense_activation_relu__prompt_kernel_wqd15:
  s_lshl_b32 s58, s4, 12
  v_add_u32 v5, s58, v17
  v_cvt_pk_bf16_f32 v120, v56, v57
  v_cvt_pk_bf16_f32 v121, v58, v59
  v_cvt_pk_bf16_f32 v122, v60, v61
  v_cvt_pk_bf16_f32 v123, v62, v63
  v_cvt_pk_bf16_f32 v124, v64, v65
  v_cvt_pk_bf16_f32 v125, v66, v67
  v_cvt_pk_bf16_f32 v126, v68, v69
  v_cvt_pk_bf16_f32 v127, v70, v71
  v_pk_max_i16 v120, v120, 0
  v_pk_max_i16 v121, v121, 0
  v_pk_max_i16 v122, v122, 0
  v_pk_max_i16 v123, v123, 0
  v_pk_max_i16 v124, v124, 0
  v_pk_max_i16 v125, v125, 0
  v_pk_max_i16 v126, v126, 0
  v_pk_max_i16 v127, v127, 0
  ds_write_b128 v5, v[120:123] offset:0
  ds_write_b128 v5, v[124:127] offset:1024
  v_cvt_pk_bf16_f32 v128, v72, v73
  v_cvt_pk_bf16_f32 v129, v74, v75
  v_cvt_pk_bf16_f32 v130, v76, v77
  v_cvt_pk_bf16_f32 v131, v78, v79
  v_cvt_pk_bf16_f32 v132, v80, v81
  v_cvt_pk_bf16_f32 v133, v82, v83
  v_cvt_pk_bf16_f32 v134, v84, v85
  v_cvt_pk_bf16_f32 v135, v86, v87
  v_pk_max_i16 v128, v128, 0
  v_pk_max_i16 v129, v129, 0
  v_pk_max_i16 v130, v130, 0
  v_pk_max_i16 v131, v131, 0
  v_pk_max_i16 v132, v132, 0
  v_pk_max_i16 v133, v133, 0
  v_pk_max_i16 v134, v134, 0
  v_pk_max_i16 v135, v135, 0
  ds_write_b128 v5, v[128:131] offset:2048
  ds_write_b128 v5, v[132:135] offset:3072
  v_cvt_pk_bf16_f32 v136, v88, v89
  v_cvt_pk_bf16_f32 v137, v90, v91
  v_cvt_pk_bf16_f32 v138, v92, v93
  v_cvt_pk_bf16_f32 v139, v94, v95
  v_cvt_pk_bf16_f32 v140, v96, v97
  v_cvt_pk_bf16_f32 v141, v98, v99
  v_cvt_pk_bf16_f32 v142, v100, v101
  v_cvt_pk_bf16_f32 v143, v102, v103
  v_pk_max_i16 v136, v136, 0
  v_pk_max_i16 v137, v137, 0
  v_pk_max_i16 v138, v138, 0
  v_pk_max_i16 v139, v139, 0
  v_pk_max_i16 v140, v140, 0
  v_pk_max_i16 v141, v141, 0
  v_pk_max_i16 v142, v142, 0
  v_pk_max_i16 v143, v143, 0
  ds_write_b128 v5, v[136:139] offset:16384
  ds_write_b128 v5, v[140:143] offset:17408
  v_cvt_pk_bf16_f32 v144, v104, v105
  v_cvt_pk_bf16_f32 v145, v106, v107
  v_cvt_pk_bf16_f32 v146, v108, v109
  v_cvt_pk_bf16_f32 v147, v110, v111
  v_cvt_pk_bf16_f32 v148, v112, v113
  v_cvt_pk_bf16_f32 v149, v114, v115
  v_cvt_pk_bf16_f32 v150, v116, v117
  v_cvt_pk_bf16_f32 v151, v118, v119
  v_pk_max_i16 v144, v144, 0
  v_pk_max_i16 v145, v145, 0
  v_pk_max_i16 v146, v146, 0
  v_pk_max_i16 v147, v147, 0
  v_pk_max_i16 v148, v148, 0
  v_pk_max_i16 v149, v149, 0
  v_pk_max_i16 v150, v150, 0
  v_pk_max_i16 v151, v151, 0
  ds_write_b128 v5, v[144:147] offset:18432
  ds_write_b128 v5, v[148:151] offset:19456
  s_waitcnt lgkmcnt(0)
  v_mov_b32 v4, 1
  s_mov_b64 exec, 1
  ds_add_u32 v3, v4 offset:4
  s_mov_b64 exec, -1
  s_mov_b32 s61, 524288
recurrent_scan__softmax_full_mha__dense_activation_relu__prompt_kernel_wc16:
  ds_read_b32 v4, v3 offset:4
  s_waitcnt lgkmcnt(0)
  v_readfirstlane_b32 s60, v4
  s_sub_u32 s61, s61, 1
  s_cbranch_scc1 recurrent_scan__softmax_full_mha__dense_activation_relu__prompt_kernel_wcd17
  s_cmp_ge_u32 s60, 4
  s_cbranch_scc1 recurrent_scan__softmax_full_mha__dense_activation_relu__prompt_kernel_wcd17
  s_sleep 4
  s_branch recurrent_scan__softmax_full_mha__dense_activation_relu__prompt_kernel_wc16
recurrent_scan__softmax_full_mha__dense_activation_relu__prompt_kernel_wcd17:
  s_lshl_b32 s8, s96, 21
  s_lshl_b32 s58, s54, 16
  s_add_u32 s8, s8, s58
  s_lshl_b32 s58, s4, 14
  s_add_u32 s8, s8, s58
  s_add_u32 s8, s8, 10485760
  s_waitcnt vmcnt(11)
  ds_read_b128 v[24:27], v17 offset:0
  ds_read_b128 v[28:31], v17 offset:16384
  ds_read_b64_tr_b16 v[40:41], v15 offset:4096
  ds_read_b64_tr_b16 v[42:43], v15 offset:5120
  ds_read_b64_tr_b16 v[44:45], v16 offset:4096
  ds_read_b64_tr_b16 v[46:47], v16 offset:5120
  s_setprio 0
  s_waitcnt vmcnt(9) lgkmcnt(0)
  v_mfma_f32_32x32x16_bf16 v[56:71], v[40:43], v[24:27], 0
  ds_read_b128 v[32:35], v17 offset:1024
  ds_read_b128 v[36:39], v17 offset:17408
  v_mfma_f32_32x32x16_bf16 v[72:87], v[44:47], v[24:27], 0
  ds_read_b64_tr_b16 v[48:49], v15 offset:6144
  ds_read_b64_tr_b16 v[50:51], v15 offset:7168
  v_mfma_f32_32x32x16_bf16 v[88:103], v[40:43], v[28:31], 0
  ds_read_b64_tr_b16 v[52:53], v16 offset:6144
  ds_read_b64_tr_b16 v[54:55], v16 offset:7168
  v_mfma_f32_32x32x16_bf16 v[104:119], v[44:47], v[28:31], 0
  s_add_u32 m0, s5, 4096
  s_add_u32 s7, s6, 98304
  buffer_load_dwordx4 v11, s[40:43], s7 offen lds
  buffer_load_dwordx4 v12, s[40:43], s7 offen offset:1024 lds
  s_waitcnt vmcnt(8) lgkmcnt(0)
  v_mfma_f32_32x32x16_bf16 v[56:71], v[48:51], v[32:35], v[56:71]
  ds_read_b128 v[24:27], v17 offset:2048
  ds_read_b128 v[28:31], v17 offset:18432
  v_mfma_f32_32x32x16_bf16 v[72:87], v[52:55], v[32:35], v[72:87]
  ds_read_b64_tr_b16 v[40:41], v15 offset:8192
  ds_read_b64_tr_b16 v[42:43], v15 offset:9216
  v_mfma_f32_32x32x16_bf16 v[88:103], v[48:51], v[36:39], v[88:103]
  ds_read_b64_tr_b16 v[44:45], v16 offset:8192
  ds_read_b64_tr_b16 v[46:47], v16 offset:9216
  v_mfma_f32_32x32x16_bf16 v[104:119], v[52:55], v[36:39], v[104:119]
  s_add_u32 m0, s5, 6144
  s_add_u32 s7, s6, 114688
  buffer_load_dwordx4 v11, s[40:43], s7 offen lds
  buffer_load_dwordx4 v12, s[40:43], s7 offen offset:1024 lds
  s_waitcnt vmcnt(8) lgkmcnt(0)
  v_mfma_f32_32x32x16_bf16 v[56:71], v[40:43], v[24:27], v[56:71]
  ds_read_b128 v[32:35], v17 offset:3072
  ds_read_b128 v[36:39], v17 offset:19456
  v_mfma_f32_32x32x16_bf16 v[72:87], v[44:47], v[24:27], v[72:87]
  ds_read_b64_tr_b16 v[48:49], v15 offset:10240
  ds_read_b64_tr_b16 v[50:51], v15 offset:11264
  v_mfma_f32_32x32x16_bf16 v[88:103], v[40:43], v[28:31], v[88:103]
  ds_read_b64_tr_b16 v[52:53], v16 offset:10240
  ds_read_b64_tr_b16 v[54:55], v16 offset:11264
  v_mfma_f32_32x32x16_bf16 v[104:119], v[44:47], v[28:31], v[104:119]
  s_add_u32 m0, s5, 8192
  s_add_u32 s7, s6, 131072
  buffer_load_dwordx4 v11, s[40:43], s7 offen lds
  buffer_load_dwordx4 v12, s[40:43], s7 offen offset:1024 lds
  s_waitcnt vmcnt(8) lgkmcnt(0)
  v_mfma_f32_32x32x16_bf16 v[56:71], v[48:51], v[32:35], v[56:71]
  ds_read_b128 v[24:27], v17 offset:4096
  ds_read_b128 v[28:31], v17 offset:20480
  v_mfma_f32_32x32x16_bf16 v[72:87], v[52:55], v[32:35], v[72:87]
  ds_read_b64_tr_b16 v[40:41], v15 offset:0
  ds_read_b64_tr_b16 v[42:43], v15 offset:1024
  v_mfma_f32_32x32x16_bf16 v[88:103], v[48:51], v[36:39], v[88:103]
  ds_read_b64_tr_b16 v[44:45], v16 offset:0
  ds_read_b64_tr_b16 v[46:47], v16 offset:1024
  ds_read_b32 v23, v22 offset:48
  v_mfma_f32_32x32x16_bf16 v[104:119], v[52:55], v[36:39], v[104:119]
  s_add_u32 m0, s5, 10240
  s_add_u32 s7, s6, 147456
  buffer_load_dwordx4 v11, s[40:43], s7 offen lds
  buffer_load_dwordx4 v12, s[40:43], s7 offen offset:1024 lds
  s_waitcnt vmcnt(8) lgkmcnt(0)
  s_setprio 3
  v_readfirstlane_b32 s60, v23
  s_setprio 3
  s_cmp_ge_u32 s60, 7
  s_cbranch_scc1 recurrent_scan__softmax_full_mha__dense_activation_relu__prompt_kernel_bo18
  s_setprio 0
recurrent_scan__softmax_full_mha__dense_activation_relu__prompt_kernel_bo18:
  v_mfma_f32_32x32x16_bf16 v[56:71], v[40:43], v[24:27], v[56:71]
  ds_read_b128 v[32:35], v17 offset:5120
  ds_read_b128 v[36:39], v17 offset:21504
  v_mfma_f32_32x32x16_bf16 v[72:87], v[44:47], v[24:27], v[72:87]
  ds_read_b64_tr_b16 v[48:49], v15 offset:2048
  ds_read_b64_tr_b16 v[50:51], v15 offset:3072
  v_mfma_f32_32x32x16_bf16 v[88:103], v[40:43], v[28:31], v[88:103]
  ds_read_b64_tr_b16 v[52:53], v16 offset:2048
  ds_read_b64_tr_b16 v[54:55], v16 offset:3072
  v_mfma_f32_32x32x16_bf16 v[104:119], v[44:47], v[28:31], v[104:119]
  s_add_u32 m0, s5, 0
  s_add_u32 s7, s6, 163840
  buffer_load_dwordx4 v11, s[40:43], s7 offen lds
  buffer_load_dwordx4 v12, s[40:43], s7 offen offset:1024 lds
  s_waitcnt vmcnt(8) lgkmcnt(0)
  v_mfma_f32_32x32x16_bf16 v[56:71], v[48:51], v[32:35], v[56:71]
  ds_read_b128 v[24:27], v17 offset:6144
  ds_read_b128 v[28:31], v17 offset:22528
  v_mfma_f32_32x32x16_bf16 v[72:87], v[52:55], v[32:35], v[72:87]
  ds_read_b64_tr_b16 v[40:41], v15 offset:4096
  ds_read_b64_tr_b16 v[42:43], v15 offset:5120
  v_mfma_f32_32x32x16_bf16 v[88:103], v[48:51], v[36:39], v[88:103]
  ds_read_b64_tr_b16 v[44:45], v16 offset:4096
  ds_read_b64_tr_b16 v[46:47], v16 offset:5120
  v_mfma_f32_32x32x16_bf16 v[104:119], v[52:55], v[36:39], v[104:119]
  s_add_u32 m0, s5, 2048
  s_add_u32 s7, s6, 180224
  buffer_load_dwordx4 v11, s[40:43], s7 offen lds
  buffer_load_dwordx4 v12, s[40:43], s7 offen offset:1024 lds
  s_waitcnt vmcnt(8) lgkmcnt(0)
  v_mfma_f32_32x32x16_bf16 v[56:71], v[40:43], v[24:27], v[56:71]
  ds_read_b128 v[32:35], v17 offset:7168
  ds_read_b128 v[36:39], v17 offset:23552
  v_mfma_f32_32x32x16_bf16 v[72:87], v[44:47], v[24:27], v[72:87]
  ds_read_b64_tr_b16 v[48:49], v15 offset:6144
  ds_read_b64_tr_b16 v[50:51], v15 offset:7168
  v_mfma_f32_32x32x16_bf16 v[88:103], v[40:43], v[28:31], v[88:103]
  ds_read_b64_tr_b16 v[52:53], v16 offset:6144
  ds_read_b64_tr_b16 v[54:55], v16 offset:7168
  v_mfma_f32_32x32x16_bf16 v[104:119], v[44:47], v[28:31], v[104:119]
  s_add_u32 m0, s5, 4096
  s_add_u32 s7, s6, 196608
  buffer_load_dwordx4 v11, s[40:43], s7 offen lds
  buffer_load_dwordx4 v12, s[40:43], s7 offen offset:1024 lds
  s_waitcnt vmcnt(8) lgkmcnt(0)
  v_mfma_f32_32x32x16_bf16 v[56:71], v[48:51], v[32:35], v[56:71]
  ds_read_b128 v[24:27], v17 offset:8192
  ds_read_b128 v[28:31], v17 offset:24576
  v_mfma_f32_32x32x16_bf16 v[72:87], v[52:55], v[32:35], v[72:87]
  ds_read_b64_tr_b16 v[40:41], v15 offset:8192
  ds_read_b64_tr_b16 v[42:43], v15 offset:9216
  v_mfma_f32_32x32x16_bf16 v[88:103], v[48:51], v[36:39], v[88:103]
  ds_read_b64_tr_b16 v[44:45], v16 offset:8192
  ds_read_b64_tr_b16 v[46:47], v16 offset:9216
  ds_read_b32 v23, v22 offset:48
  v_mfma_f32_32x32x16_bf16 v[104:119], v[52:55], v[36:39], v[104:119]
  s_add_u32 m0, s5, 6144
  s_add_u32 s7, s6, 212992
  buffer_load_dwordx4 v11, s[40:43], s7 offen lds
  buffer_load_dwordx4 v12, s[40:43], s7 offen offset:1024 lds
  s_waitcnt vmcnt(8) lgkmcnt(0)
  s_setprio 3
  v_readfirstlane_b32 s60, v23
  s_setprio 3
  s_cmp_ge_u32 s60, 7
  s_cbranch_scc1 recurrent_scan__softmax_full_mha__dense_activation_relu__prompt_kernel_bo19
  s_setprio 0
recurrent_scan__softmax_full_mha__dense_activation_relu__prompt_kernel_bo19:
  v_mfma_f32_32x32x16_bf16 v[56:71], v[40:43], v[24:27], v[56:71]
  ds_read_b128 v[32:35], v17 offset:9216
  ds_read_b128 v[36:39], v17 offset:25600
  v_mfma_f32_32x32x16_bf16 v[72:87], v[44:47], v[24:27], v[72:87]
  ds_read_b64_tr_b16 v[48:49], v15 offset:10240
  ds_read_b64_tr_b16 v[50:51], v15 offset:11264
  v_mfma_f32_32x32x16_bf16 v[88:103], v[40:43], v[28:31], v[88:103]
  ds_read_b64_tr_b16 v[52:53], v16 offset:10240
  ds_read_b64_tr_b16 v[54:55], v16 offset:11264
  v_mfma_f32_32x32x16_bf16 v[104:119], v[44:47], v[28:31], v[104:119]
  s_add_u32 m0, s5, 8192
  s_add_u32 s7, s6, 229376
  buffer_load_dwordx4 v11, s[40:43], s7 offen lds
  buffer_load_dwordx4 v12, s[40:43], s7 offen offset:1024 lds
  s_waitcnt vmcnt(8) lgkmcnt(0)
  v_mfma_f32_32x32x16_bf16 v[56:71], v[48:51], v[32:35], v[56:71]
  ds_read_b128 v[24:27], v17 offset:10240
  ds_read_b128 v[28:31], v17 offset:26624
  v_mfma_f32_32x32x16_bf16 v[72:87], v[52:55], v[32:35], v[72:87]
  ds_read_b64_tr_b16 v[40:41], v15 offset:0
  ds_read_b64_tr_b16 v[42:43], v15 offset:1024
  v_mfma_f32_32x32x16_bf16 v[88:103], v[48:51], v[36:39], v[88:103]
  ds_read_b64_tr_b16 v[44:45], v16 offset:0
  ds_read_b64_tr_b16 v[46:47], v16 offset:1024
  v_mfma_f32_32x32x16_bf16 v[104:119], v[52:55], v[36:39], v[104:119]
  s_add_u32 m0, s5, 10240
  s_add_u32 s7, s6, 245760
  buffer_load_dwordx4 v11, s[40:43], s7 offen lds
  buffer_load_dwordx4 v12, s[40:43], s7 offen offset:1024 lds
  s_waitcnt vmcnt(8) lgkmcnt(0)
  v_mfma_f32_32x32x16_bf16 v[56:71], v[40:43], v[24:27], v[56:71]
  ds_read_b128 v[32:35], v17 offset:11264
  ds_read_b128 v[36:39], v17 offset:27648
  v_mfma_f32_32x32x16_bf16 v[72:87], v[44:47], v[24:27], v[72:87]
  ds_read_b64_tr_b16 v[48:49], v15 offset:2048
  ds_read_b64_tr_b16 v[50:51], v15 offset:3072
  v_mfma_f32_32x32x16_bf16 v[88:103], v[40:43], v[28:31], v[88:103]
  ds_read_b64_tr_b16 v[52:53], v16 offset:2048
  ds_read_b64_tr_b16 v[54:55], v16 offset:3072
  v_mfma_f32_32x32x16_bf16 v[104:119], v[44:47], v[28:31], v[104:119]
  s_add_u32 m0, s5, 0
  s_add_u32 s7, s6, 128
  buffer_load_dwordx4 v11, s[40:43], s7 offen lds
  buffer_load_dwordx4 v12, s[40:43], s7 offen offset:1024 lds
  s_waitcnt vmcnt(8) lgkmcnt(0)
  v_mfma_f32_32x32x16_bf16 v[56:71], v[48:51], v[32:35], v[56:71]
  ds_read_b128 v[24:27], v17 offset:12288
  ds_read_b128 v[28:31], v17 offset:28672
  v_mfma_f32_32x32x16_bf16 v[72:87], v[52:55], v[32:35], v[72:87]
  ds_read_b64_tr_b16 v[40:41], v15 offset:4096
  ds_read_b64_tr_b16 v[42:43], v15 offset:5120
  v_mfma_f32_32x32x16_bf16 v[88:103], v[48:51], v[36:39], v[88:103]
  ds_read_b64_tr_b16 v[44:45], v16 offset:4096
  ds_read_b64_tr_b16 v[46:47], v16 offset:5120
  ds_read_b32 v23, v22 offset:48
  v_mfma_f32_32x32x16_bf16 v[104:119], v[52:55], v[36:39], v[104:119]
  s_add_u32 m0, s5, 2048
  s_add_u32 s7, s6, 16512
  buffer_load_dwordx4 v11, s[40:43], s7 offen lds
  buffer_load_dwordx4 v12, s[40:43], s7 offen offset:1024 lds
  s_waitcnt vmcnt(8) lgkmcnt(0)
  s_lshl_b32 s58, s57, 2
  s_add_u32 s58, s58, s4
  s_lshl_b32 s58, s58, 12
  v_lshlrev_b32 v4, 7, v1
  s_mov_b64 exec, 0xffffffff
  buffer_load_dword v162, v4, s[32:35], s58 offen
  s_mov_b64 exec, -1
  s_setprio 3
  v_readfirstlane_b32 s60, v23
  s_setprio 3
  s_cmp_ge_u32 s60, 8
  s_cbranch_scc1 recurrent_scan__softmax_full_mha__dense_activation_relu__prompt_kernel_bo20
  s_setprio 0
recurrent_scan__softmax_full_mha__dense_activation_relu__prompt_kernel_bo20:
  v_mfma_f32_32x32x16_bf16 v[56:71], v[40:43], v[24:27], v[56:71]
  ds_read_b128 v[32:35], v17 offset:13312
  ds_read_b128 v[36:39], v17 offset:29696
  v_mfma_f32_32x32x16_bf16 v[72:87], v[44:47], v[24:27], v[72:87]
  ds_read_b64_tr_b16 v[48:49], v15 offset:6144
  ds_read_b64_tr_b16 v[50:51], v15 offset:7168
  v_mfma_f32_32x32x16_bf16 v[88:103], v[40:43], v[28:31], v[88:103]
  ds_read_b64_tr_b16 v[52:53], v16 offset:6144
  ds_read_b64_tr_b16 v[54:55], v16 offset:7168
  v_mfma_f32_32x32x16_bf16 v[104:119], v[44:47], v[28:31], v[104:119]
  s_add_u32 m0, s5, 4096
  s_add_u32 s7, s6, 32896
  buffer_load_dwordx4 v11, s[40:43], s7 offen lds
  buffer_load_dwordx4 v12, s[40:43], s7 offen offset:1024 lds
  s_waitcnt vmcnt(9) lgkmcnt(0)
  v_mfma_f32_32x32x16_bf16 v[56:71], v[48:51], v[32:35], v[56:71]
  ds_read_b128 v[24:27], v17 offset:14336
  ds_read_b128 v[28:31], v17 offset:30720
  v_mfma_f32_32x32x16_bf16 v[72:87], v[52:55], v[32:35], v[72:87]
  ds_read_b64_tr_b16 v[40:41], v15 offset:8192
  ds_read_b64_tr_b16 v[42:43], v15 offset:9216
  v_mfma_f32_32x32x16_bf16 v[88:103], v[48:51], v[36:39], v[88:103]
  ds_read_b64_tr_b16 v[44:45], v16 offset:8192
  ds_read_b64_tr_b16 v[46:47], v16 offset:9216
  v_mfma_f32_32x32x16_bf16 v[104:119], v[52:55], v[36:39], v[104:119]
  s_add_u32 m0, s5, 6144
  s_add_u32 s7, s6, 49280
  buffer_load_dwordx4 v11, s[40:43], s7 offen lds
  buffer_load_dwordx4 v12, s[40:43], s7 offen offset:1024 lds
  s_waitcnt vmcnt(9) lgkmcnt(0)
  v_mfma_f32_32x32x16_bf16 v[56:71], v[40:43], v[24:27], v[56:71]
  ds_read_b128 v[32:35], v17 offset:15360
  ds_read_b128 v[36:39], v17 offset:31744
  v_mfma_f32_32x32x16_bf16 v[72:87], v[44:47], v[24:27], v[72:87]
  ds_read_b64_tr_b16 v[48:49], v15 offset:10240
  ds_read_b64_tr_b16 v[50:51], v15 offset:11264
  v_mfma_f32_32x32x16_bf16 v[88:103], v[40:43], v[28:31], v[88:103]
  ds_read_b64_tr_b16 v[52:53], v16 offset:10240
  ds_read_b64_tr_b16 v[54:55], v16 offset:11264
  v_mfma_f32_32x32x16_bf16 v[104:119], v[44:47], v[28:31], v[104:119]
  s_add_u32 m0, s5, 8192
  s_add_u32 s7, s6, 65664
  buffer_load_dwordx4 v11, s[40:43], s7 offen lds
  buffer_load_dwordx4 v12, s[40:43], s7 offen offset:1024 lds
  s_waitcnt lgkmcnt(0)
  v_mfma_f32_32x32x16_bf16 v[56:71], v[48:51], v[32:35], v[56:71]
  v_mfma_f32_32x32x16_bf16 v[72:87], v[52:55], v[32:35], v[72:87]
  v_mfma_f32_32x32x16_bf16 v[88:103], v[48:51], v[36:39], v[88:103]
  v_mfma_f32_32x32x16_bf16 v[104:119], v[52:55], v[36:39], v[104:119]
  s_add_u32 m0, s5, 10240
  s_add_u32 s7, s6, 82048
  buffer_load_dwordx4 v11, s[40:43], s7 offen lds
  buffer_load_dwordx4 v12, s[40:43], s7 offen offset:1024 lds
  s_setprio 2
  s_add_u32 s9, s8, 0
  s_nop 2
  v_cvt_pk_bf16_f32 v120, v56, v57
  v_cvt_pk_bf16_f32 v121, v58, v59
  v_cvt_pk_bf16_f32 v122, v60, v61
  v_cvt_pk_bf16_f32 v123, v62, v63
  v_cvt_pk_bf16_f32 v124, v64, v65
  v_cvt_pk_bf16_f32 v125, v66, v67
  v_cvt_pk_bf16_f32 v126, v68, v69
  v_cvt_pk_bf16_f32 v127, v70, v71
  buffer_store_dwordx4 v[120:123], v2, s[48:51], s9 offen offset:0 sc1
  buffer_store_dwordx4 v[124:127], v2, s[48:51], s9 offen offset:1024 sc1
  v_cvt_pk_bf16_f32 v128, v72, v73
  v_cvt_pk_bf16_f32 v129, v74, v75
  v_cvt_pk_bf16_f32 v130, v76, v77
  v_cvt_pk_bf16_f32 v131, v78, v79
  v_cvt_pk_bf16_f32 v132, v80, v81
  v_cvt_pk_bf16_f32 v133, v82, v83
  v_cvt_pk_bf16_f32 v134, v84, v85
  v_cvt_pk_bf16_f32 v135, v86, v87
  buffer_store_dwordx4 v[128:131], v2, s[48:51], s9 offen offset:2048 sc1
  buffer_store_dwordx4 v[132:135], v2, s[48:51], s9 offen offset:3072 sc1
  s_add_u32 s9, s8, 4096
  v_cvt_pk_bf16_f32 v136, v88, v89
  v_cvt_pk_bf16_f32 v137, v90, v91
  v_cvt_pk_bf16_f32 v138, v92, v93
  v_cvt_pk_bf16_f32 v139, v94, v95
  v_cvt_pk_bf16_f32 v140, v96, v97
  v_cvt_pk_bf16_f32 v141, v98, v99
  v_cvt_pk_bf16_f32 v142, v100, v101
  v_cvt_pk_bf16_f32 v143, v102, v103
  buffer_store_dwordx4 v[136:139], v2, s[48:51], s9 offen offset:0 sc1
  buffer_store_dwordx4 v[140:143], v2, s[48:51], s9 offen offset:1024 sc1
  v_cvt_pk_bf16_f32 v144, v104, v105
  v_cvt_pk_bf16_f32 v145, v106, v107
  v_cvt_pk_bf16_f32 v146, v108, v109
  v_cvt_pk_bf16_f32 v147, v110, v111
  v_cvt_pk_bf16_f32 v148, v112, v113
  v_cvt_pk_bf16_f32 v149, v114, v115
  v_cvt_pk_bf16_f32 v150, v116, v117
  v_cvt_pk_bf16_f32 v151, v118, v119
  buffer_store_dwordx4 v[144:147], v2, s[48:51], s9 offen offset:2048 sc1
  buffer_store_dwordx4 v[148:151], v2, s[48:51], s9 offen offset:3072 sc1
  s_waitcnt vmcnt(19)
  ds_read_b128 v[24:27], v17 offset:0
  ds_read_b128 v[28:31], v17 offset:16384
  ds_read_b64_tr_b16 v[40:41], v15 offset:0
  ds_read_b64_tr_b16 v[42:43], v15 offset:1024
  ds_read_b64_tr_b16 v[44:45], v16 offset:0
  ds_read_b64_tr_b16 v[46:47], v16 offset:1024
  s_setprio 0
  s_waitcnt vmcnt(17) lgkmcnt(0)
  v_mfma_f32_32x32x16_bf16 v[56:71], v[40:43], v[24:27], 0
  ds_read_b128 v[32:35], v17 offset:1024
  ds_read_b128 v[36:39], v17 offset:17408
  v_mfma_f32_32x32x16_bf16 v[72:87], v[44:47], v[24:27], 0
  ds_read_b64_tr_b16 v[48:49], v15 offset:2048
  ds_read_b64_tr_b16 v[50:51], v15 offset:3072
  v_mfma_f32_32x32x16_bf16 v[88:103], v[40:43], v[28:31], 0
  ds_read_b64_tr_b16 v[52:53], v16 offset:2048
  ds_read_b64_tr_b16 v[54:55], v16 offset:3072
  v_mfma_f32_32x32x16_bf16 v[104:119], v[44:47], v[28:31], 0
  s_add_u32 m0, s5, 0
  s_add_u32 s7, s6, 98432
  buffer_load_dwordx4 v11, s[40:43], s7 offen lds
  buffer_load_dwordx4 v12, s[40:43], s7 offen offset:1024 lds
  s_waitcnt vmcnt(16) lgkmcnt(0)
  v_mfma_f32_32x32x16_bf16 v[56:71], v[48:51], v[32:35], v[56:71]
  ds_read_b128 v[24:27], v17 offset:2048
  ds_read_b128 v[28:31], v17 offset:18432
  v_mfma_f32_32x32x16_bf16 v[72:87], v[52:55], v[32:35], v[72:87]
  ds_read_b64_tr_b16 v[40:41], v15 offset:4096
  ds_read_b64_tr_b16 v[42:43], v15 offset:5120
  v_mfma_f32_32x32x16_bf16 v[88:103], v[48:51], v[36:39], v[88:103]
  ds_read_b64_tr_b16 v[44:45], v16 offset:4096
  ds_read_b64_tr_b16 v[46:47], v16 offset:5120
  v_mfma_f32_32x32x16_bf16 v[104:119], v[52:55], v[36:39], v[104:119]
  s_add_u32 m0, s5, 2048
  s_add_u32 s7, s6, 114816
  buffer_load_dwordx4 v11, s[40:43], s7 offen lds
  buffer_load_dwordx4 v12, s[40:43], s7 offen offset:1024 lds
  s_waitcnt vmcnt(16) lgkmcnt(0)
  v_mfma_f32_32x32x16_bf16 v[56:71], v[40:43], v[24:27], v[56:71]
  ds_read_b128 v[32:35], v17 offset:3072
  ds_read_b128 v[36:39], v17 offset:19456
  v_mfma_f32_32x32x16_bf16 v[72:87], v[44:47], v[24:27], v[72:87]
  ds_read_b64_tr_b16 v[48:49], v15 offset:6144
  ds_read_b64_tr_b16 v[50:51], v15 offset:7168
  v_mfma_f32_32x32x16_bf16 v[88:103], v[40:43], v[28:31], v[88:103]
  ds_read_b64_tr_b16 v[52:53], v16 offset:6144
  ds_read_b64_tr_b16 v[54:55], v16 offset:7168
  v_mfma_f32_32x32x16_bf16 v[104:119], v[44:47], v[28:31], v[104:119]
  s_add_u32 m0, s5, 4096
  s_add_u32 s7, s6, 131200
  buffer_load_dwordx4 v11, s[40:43], s7 offen lds
  buffer_load_dwordx4 v12, s[40:43], s7 offen offset:1024 lds
  s_waitcnt vmcnt(16) lgkmcnt(0)
  v_mfma_f32_32x32x16_bf16 v[56:71], v[48:51], v[32:35], v[56:71]
  ds_read_b128 v[24:27], v17 offset:4096
  ds_read_b128 v[28:31], v17 offset:20480
  v_mfma_f32_32x32x16_bf16 v[72:87], v[52:55], v[32:35], v[72:87]
  ds_read_b64_tr_b16 v[40:41], v15 offset:8192
  ds_read_b64_tr_b16 v[42:43], v15 offset:9216
  v_mfma_f32_32x32x16_bf16 v[88:103], v[48:51], v[36:39], v[88:103]
  ds_read_b64_tr_b16 v[44:45], v16 offset:8192
  ds_read_b64_tr_b16 v[46:47], v16 offset:9216
  ds_read_b32 v23, v22 offset:48
  v_mfma_f32_32x32x16_bf16 v[104:119], v[52:55], v[36:39], v[104:119]
  s_add_u32 m0, s5, 6144
  s_add_u32 s7, s6, 147584
  buffer_load_dwordx4 v11, s[40:43], s7 offen lds
  buffer_load_dwordx4 v12, s[40:43], s7 offen offset:1024 lds
  s_waitcnt vmcnt(16) lgkmcnt(0)
  s_setprio 3
  v_readfirstlane_b32 s60, v23
  s_setprio 3
  s_cmp_ge_u32 s60, 10
  s_cbranch_scc1 recurrent_scan__softmax_full_mha__dense_activation_relu__prompt_kernel_bo21
  s_setprio 0
recurrent_scan__softmax_full_mha__dense_activation_relu__prompt_kernel_bo21:
  v_mfma_f32_32x32x16_bf16 v[56:71], v[40:43], v[24:27], v[56:71]
  ds_read_b128 v[32:35], v17 offset:5120
  ds_read_b128 v[36:39], v17 offset:21504
  v_mfma_f32_32x32x16_bf16 v[72:87], v[44:47], v[24:27], v[72:87]
  ds_read_b64_tr_b16 v[48:49], v15 offset:10240
  ds_read_b64_tr_b16 v[50:51], v15 offset:11264
  v_mfma_f32_32x32x16_bf16 v[88:103], v[40:43], v[28:31], v[88:103]
  ds_read_b64_tr_b16 v[52:53], v16 offset:10240
  ds_read_b64_tr_b16 v[54:55], v16 offset:11264
  v_mfma_f32_32x32x16_bf16 v[104:119], v[44:47], v[28:31], v[104:119]
  s_add_u32 m0, s5, 8192
  s_add_u32 s7, s6, 163968
  buffer_load_dwordx4 v11, s[40:43], s7 offen lds
  buffer_load_dwordx4 v12, s[40:43], s7 offen offset:1024 lds
  s_waitcnt vmcnt(8) lgkmcnt(0)
  v_mfma_f32_32x32x16_bf16 v[56:71], v[48:51], v[32:35], v[56:71]
  ds_read_b128 v[24:27], v17 offset:6144
  ds_read_b128 v[28:31], v17 offset:22528
  v_mfma_f32_32x32x16_bf16 v[72:87], v[52:55], v[32:35], v[72:87]
  ds_read_b64_tr_b16 v[40:41], v15 offset:0
  ds_read_b64_tr_b16 v[42:43], v15 offset:1024
  v_mfma_f32_32x32x16_bf16 v[88:103], v[48:51], v[36:39], v[88:103]
  ds_read_b64_tr_b16 v[44:45], v16 offset:0
  ds_read_b64_tr_b16 v[46:47], v16 offset:1024
  v_mfma_f32_32x32x16_bf16 v[104:119], v[52:55], v[36:39], v[104:119]
  s_add_u32 m0, s5, 10240
  s_add_u32 s7, s6, 180352
  buffer_load_dwordx4 v11, s[40:43], s7 offen lds
  buffer_load_dwordx4 v12, s[40:43], s7 offen offset:1024 lds
  s_waitcnt vmcnt(8) lgkmcnt(0)
  v_mfma_f32_32x32x16_bf16 v[56:71], v[40:43], v[24:27], v[56:71]
  ds_read_b128 v[32:35], v17 offset:7168
  ds_read_b128 v[36:39], v17 offset:23552
  v_mfma_f32_32x32x16_bf16 v[72:87], v[44:47], v[24:27], v[72:87]
  ds_read_b64_tr_b16 v[48:49], v15 offset:2048
  ds_read_b64_tr_b16 v[50:51], v15 offset:3072
  v_mfma_f32_32x32x16_bf16 v[88:103], v[40:43], v[28:31], v[88:103]
  ds_read_b64_tr_b16 v[52:53], v16 offset:2048
  ds_read_b64_tr_b16 v[54:55], v16 offset:3072
  v_mfma_f32_32x32x16_bf16 v[104:119], v[44:47], v[28:31], v[104:119]
  s_add_u32 m0, s5, 0
  s_add_u32 s7, s6, 196736
  buffer_load_dwordx4 v11, s[40:43], s7 offen lds
  buffer_load_dwordx4 v12, s[40:43], s7 offen offset:1024 lds
  s_waitcnt vmcnt(8) lgkmcnt(0)
  v_mfma_f32_32x32x16_bf16 v[56:71], v[48:51], v[32:35], v[56:71]
  ds_read_b128 v[24:27], v17 offset:8192
  ds_read_b128 v[28:31], v17 offset:24576
  v_mfma_f32_32x32x16_bf16 v[72:87], v[52:55], v[32:35], v[72:87]
  ds_read_b64_tr_b16 v[40:41], v15 offset:4096
  ds_read_b64_tr_b16 v[42:43], v15 offset:5120
  v_mfma_f32_32x32x16_bf16 v[88:103], v[48:51], v[36:39], v[88:103]
  ds_read_b64_tr_b16 v[44:45], v16 offset:4096
  ds_read_b64_tr_b16 v[46:47], v16 offset:5120
  ds_read_b32 v23, v22 offset:48
  v_mfma_f32_32x32x16_bf16 v[104:119], v[52:55], v[36:39], v[104:119]
  s_add_u32 m0, s5, 2048
  s_add_u32 s7, s6, 213120
  buffer_load_dwordx4 v11, s[40:43], s7 offen lds
  buffer_load_dwordx4 v12, s[40:43], s7 offen offset:1024 lds
  s_waitcnt vmcnt(8) lgkmcnt(0)
  s_setprio 3
  v_readfirstlane_b32 s60, v23
  s_setprio 3
  s_cmp_ge_u32 s60, 11
  s_cbranch_scc1 recurrent_scan__softmax_full_mha__dense_activation_relu__prompt_kernel_bo22
  s_setprio 0
recurrent_scan__softmax_full_mha__dense_activation_relu__prompt_kernel_bo22:
  v_mfma_f32_32x32x16_bf16 v[56:71], v[40:43], v[24:27], v[56:71]
  ds_read_b128 v[32:35], v17 offset:9216
  ds_read_b128 v[36:39], v17 offset:25600
  v_mfma_f32_32x32x16_bf16 v[72:87], v[44:47], v[24:27], v[72:87]
  ds_read_b64_tr_b16 v[48:49], v15 offset:6144
  ds_read_b64_tr_b16 v[50:51], v15 offset:7168
  v_mfma_f32_32x32x16_bf16 v[88:103], v[40:43], v[28:31], v[88:103]
  ds_read_b64_tr_b16 v[52:53], v16 offset:6144
  ds_read_b64_tr_b16 v[54:55], v16 offset:7168
  v_mfma_f32_32x32x16_bf16 v[104:119], v[44:47], v[28:31], v[104:119]
  s_add_u32 m0, s5, 4096
  s_add_u32 s7, s6, 229504
  buffer_load_dwordx4 v11, s[40:43], s7 offen lds
  buffer_load_dwordx4 v12, s[40:43], s7 offen offset:1024 lds
  s_waitcnt vmcnt(8) lgkmcnt(0)
  v_mfma_f32_32x32x16_bf16 v[56:71], v[48:51], v[32:35], v[56:71]
  ds_read_b128 v[24:27], v17 offset:10240
  ds_read_b128 v[28:31], v17 offset:26624
  v_mfma_f32_32x32x16_bf16 v[72:87], v[52:55], v[32:35], v[72:87]
  ds_read_b64_tr_b16 v[40:41], v15 offset:8192
  ds_read_b64_tr_b16 v[42:43], v15 offset:9216
  v_mfma_f32_32x32x16_bf16 v[88:103], v[48:51], v[36:39], v[88:103]
  ds_read_b64_tr_b16 v[44:45], v16 offset:8192
  ds_read_b64_tr_b16 v[46:47], v16 offset:9216
  v_mfma_f32_32x32x16_bf16 v[104:119], v[52:55], v[36:39], v[104:119]
  s_add_u32 m0, s5, 6144
  s_add_u32 s7, s6, 245888
  buffer_load_dwordx4 v11, s[40:43], s7 offen lds
  buffer_load_dwordx4 v12, s[40:43], s7 offen offset:1024 lds
  s_waitcnt vmcnt(8) lgkmcnt(0)
  v_mfma_f32_32x32x16_bf16 v[56:71], v[40:43], v[24:27], v[56:71]
  ds_read_b128 v[32:35], v17 offset:11264
  ds_read_b128 v[36:39], v17 offset:27648
  v_mfma_f32_32x32x16_bf16 v[72:87], v[44:47], v[24:27], v[72:87]
  ds_read_b64_tr_b16 v[48:49], v15 offset:10240
  ds_read_b64_tr_b16 v[50:51], v15 offset:11264
  v_mfma_f32_32x32x16_bf16 v[88:103], v[40:43], v[28:31], v[88:103]
  ds_read_b64_tr_b16 v[52:53], v16 offset:10240
  ds_read_b64_tr_b16 v[54:55], v16 offset:11264
  v_mfma_f32_32x32x16_bf16 v[104:119], v[44:47], v[28:31], v[104:119]
  s_waitcnt vmcnt(6) lgkmcnt(0)
  v_mfma_f32_32x32x16_bf16 v[56:71], v[48:51], v[32:35], v[56:71]
  ds_read_b128 v[24:27], v17 offset:12288
  ds_read_b128 v[28:31], v17 offset:28672
  v_mfma_f32_32x32x16_bf16 v[72:87], v[52:55], v[32:35], v[72:87]
  ds_read_b64_tr_b16 v[40:41], v15 offset:0
  ds_read_b64_tr_b16 v[42:43], v15 offset:1024
  v_mfma_f32_32x32x16_bf16 v[88:103], v[48:51], v[36:39], v[88:103]
  ds_read_b64_tr_b16 v[44:45], v16 offset:0
  ds_read_b64_tr_b16 v[46:47], v16 offset:1024
  ds_read_b32 v23, v22 offset:48
  v_mfma_f32_32x32x16_bf16 v[104:119], v[52:55], v[36:39], v[104:119]
  s_waitcnt vmcnt(4) lgkmcnt(0)
  s_setprio 3
  v_readfirstlane_b32 s60, v23
  s_setprio 3
  s_cmp_ge_u32 s60, 12
  s_cbranch_scc1 recurrent_scan__softmax_full_mha__dense_activation_relu__prompt_kernel_bo23
  s_setprio 0
recurrent_scan__softmax_full_mha__dense_activation_relu__prompt_kernel_bo23:
  v_mfma_f32_32x32x16_bf16 v[56:71], v[40:43], v[24:27], v[56:71]
  ds_read_b128 v[32:35], v17 offset:13312
  ds_read_b128 v[36:39], v17 offset:29696
  v_mfma_f32_32x32x16_bf16 v[72:87], v[44:47], v[24:27], v[72:87]
  ds_read_b64_tr_b16 v[48:49], v15 offset:2048
  ds_read_b64_tr_b16 v[50:51], v15 offset:3072
  v_mfma_f32_32x32x16_bf16 v[88:103], v[40:43], v[28:31], v[88:103]
  ds_read_b64_tr_b16 v[52:53], v16 offset:2048
  ds_read_b64_tr_b16 v[54:55], v16 offset:3072
  v_mfma_f32_32x32x16_bf16 v[104:119], v[44:47], v[28:31], v[104:119]
  s_waitcnt vmcnt(2) lgkmcnt(0)
  v_mfma_f32_32x32x16_bf16 v[56:71], v[48:51], v[32:35], v[56:71]
  ds_read_b128 v[24:27], v17 offset:14336
  ds_read_b128 v[28:31], v17 offset:30720
  v_mfma_f32_32x32x16_bf16 v[72:87], v[52:55], v[32:35], v[72:87]
  ds_read_b64_tr_b16 v[40:41], v15 offset:4096
  ds_read_b64_tr_b16 v[42:43], v15 offset:5120
  v_mfma_f32_32x32x16_bf16 v[88:103], v[48:51], v[36:39], v[88:103]
  ds_read_b64_tr_b16 v[44:45], v16 offset:4096
  ds_read_b64_tr_b16 v[46:47], v16 offset:5120
  v_mfma_f32_32x32x16_bf16 v[104:119], v[52:55], v[36:39], v[104:119]
  s_waitcnt vmcnt(0) lgkmcnt(0)
  v_mfma_f32_32x32x16_bf16 v[56:71], v[40:43], v[24:27], v[56:71]
  ds_read_b128 v[32:35], v17 offset:15360
  ds_read_b128 v[36:39], v17 offset:31744
  v_mfma_f32_32x32x16_bf16 v[72:87], v[44:47], v[24:27], v[72:87]
  ds_read_b64_tr_b16 v[48:49], v15 offset:6144
  ds_read_b64_tr_b16 v[50:51], v15 offset:7168
  v_mfma_f32_32x32x16_bf16 v[88:103], v[40:43], v[28:31], v[88:103]
  ds_read_b64_tr_b16 v[52:53], v16 offset:6144
  ds_read_b64_tr_b16 v[54:55], v16 offset:7168
  v_mfma_f32_32x32x16_bf16 v[104:119], v[44:47], v[28:31], v[104:119]
  s_waitcnt lgkmcnt(0)
  v_mfma_f32_32x32x16_bf16 v[56:71], v[48:51], v[32:35], v[56:71]
  v_mfma_f32_32x32x16_bf16 v[72:87], v[52:55], v[32:35], v[72:87]
  v_mfma_f32_32x32x16_bf16 v[88:103], v[48:51], v[36:39], v[88:103]
  v_mfma_f32_32x32x16_bf16 v[104:119], v[52:55], v[36:39], v[104:119]
  s_setprio 2
  v_mov_b32 v4, 1
  s_mov_b64 exec, 1
  ds_add_u32 v3, v4 offset:8
  s_mov_b64 exec, -1
  s_add_u32 s9, s8, 8192
  s_nop 2
  v_cvt_pk_bf16_f32 v120, v56, v57
  v_cvt_pk_bf16_f32 v121, v58, v59
  v_cvt_pk_bf16_f32 v122, v60, v61
  v_cvt_pk_bf16_f32 v123, v62, v63
  v_cvt_pk_bf16_f32 v124, v64, v65
  v_cvt_pk_bf16_f32 v125, v66, v67
  v_cvt_pk_bf16_f32 v126, v68, v69
  v_cvt_pk_bf16_f32 v127, v70, v71
  buffer_store_dwordx4 v[120:123], v2, s[48:51], s9 offen offset:0 sc1
  buffer_store_dwordx4 v[124:127], v2, s[48:51], s9 offen offset:1024 sc1
  v_cvt_pk_bf16_f32 v128, v72, v73
  v_cvt_pk_bf16_f32 v129, v74, v75
  v_cvt_pk_bf16_f32 v130, v76, v77
  v_cvt_pk_bf16_f32 v131, v78, v79
  v_cvt_pk_bf16_f32 v132, v80, v81
  v_cvt_pk_bf16_f32 v133, v82, v83
  v_cvt_pk_bf16_f32 v134, v84, v85
  v_cvt_pk_bf16_f32 v135, v86, v87
  buffer_store_dwordx4 v[128:131], v2, s[48:51], s9 offen offset:2048 sc1
  buffer_store_dwordx4 v[132:135], v2, s[48:51], s9 offen offset:3072 sc1
  s_add_u32 s9, s8, 12288
  v_cvt_pk_bf16_f32 v136, v88, v89
  v_cvt_pk_bf16_f32 v137, v90, v91
  v_cvt_pk_bf16_f32 v138, v92, v93
  v_cvt_pk_bf16_f32 v139, v94, v95
  v_cvt_pk_bf16_f32 v140, v96, v97
  v_cvt_pk_bf16_f32 v141, v98, v99
  v_cvt_pk_bf16_f32 v142, v100, v101
  v_cvt_pk_bf16_f32 v143, v102, v103
  buffer_store_dwordx4 v[136:139], v2, s[48:51], s9 offen offset:0 sc1
  buffer_store_dwordx4 v[140:143], v2, s[48:51], s9 offen offset:1024 sc1
  v_cvt_pk_bf16_f32 v144, v104, v105
  v_cvt_pk_bf16_f32 v145, v106, v107
  v_cvt_pk_bf16_f32 v146, v108, v109
  v_cvt_pk_bf16_f32 v147, v110, v111
  v_cvt_pk_bf16_f32 v148, v112, v113
  v_cvt_pk_bf16_f32 v149, v114, v115
  v_cvt_pk_bf16_f32 v150, v116, v117
  v_cvt_pk_bf16_f32 v151, v118, v119
  buffer_store_dwordx4 v[144:147], v2, s[48:51], s9 offen offset:2048 sc1
  buffer_store_dwordx4 v[148:151], v2, s[48:51], s9 offen offset:3072 sc1
  s_lshl_b32 s58, s54, 10
  s_lshl_b32 s59, s96, 7
  s_add_u32 s58, s58, s59
  s_add_u32 s58, s58, 25198592
  s_waitcnt vmcnt(0)
  v_mov_b32 v4, 1
  s_mov_b64 exec, 1
  ds_add_rtn_u32 v5, v3, v4 offset:20
  s_mov_b64 exec, -1
  s_waitcnt lgkmcnt(0)
  v_readfirstlane_b32 s60, v5
  s_nop 0
  s_cmp_eq_u32 s60, 3
  s_cbranch_scc0 recurrent_scan__softmax_full_mha__dense_activation_relu__prompt_kernel_nf24
  v_mov_b32 v5, s52
  v_mov_b32 v4, 0
  s_mov_b64 exec, 1
  buffer_store_dword v5, v4, s[48:51], s58 offen sc1
  s_mov_b64 exec, -1
recurrent_scan__softmax_full_mha__dense_activation_relu__prompt_kernel_nf24:
  s_branch L_ffn_tail
L_ffn_skip:
  s_waitcnt vmcnt(0)
  v_mov_b32 v4, 1
  s_mov_b64 exec, 1
  ds_add_rtn_u32 v5, v3, v4 offset:16
  s_mov_b64 exec, -1
  s_waitcnt lgkmcnt(0)
  v_readfirstlane_b32 s60, v5
  s_nop 0
  s_cmp_eq_u32 s60, 3
  s_cbranch_scc0 recurrent_scan__softmax_full_mha__dense_activation_relu__prompt_kernel_nf25
  v_mov_b32 v5, s52
  v_mov_b32 v4, 0
  s_mov_b64 exec, 1
  buffer_store_dword v5, v4, s[48:51], s23 offen sc1
  s_mov_b64 exec, -1
recurrent_scan__softmax_full_mha__dense_activation_relu__prompt_kernel_nf25:
  s_mov_b32 s61, 524288
recurrent_scan__softmax_full_mha__dense_activation_relu__prompt_kernel_wq26:
  ds_read_b32 v4, v3 offset:0
  s_waitcnt lgkmcnt(0)
  v_readfirstlane_b32 s60, v4
  s_sub_u32 s61, s61, 1
  s_cbranch_scc1 recurrent_scan__softmax_full_mha__dense_activation_relu__prompt_kernel_wqd27
  s_cmp_ge_u32 s60, 4
  s_cbranch_scc1 recurrent_scan__softmax_full_mha__dense_activation_relu__prompt_kernel_wqd27
  s_sleep 2
  s_branch recurrent_scan__softmax_full_mha__dense_activation_relu__prompt_kernel_wq26
recurrent_scan__softmax_full_mha__dense_activation_relu__prompt_kernel_wqd27:
  s_mov_b32 s61, 524288
recurrent_scan__softmax_full_mha__dense_activation_relu__prompt_kernel_sg28:
  ds_read_b32 v4, v3 offset:48
  s_waitcnt lgkmcnt(0)
  v_readfirstlane_b32 s60, v4
  s_sub_u32 s61, s61, 1
  s_cbranch_scc1 recurrent_scan__softmax_full_mha__dense_activation_relu__prompt_kernel_sgd29
  s_cmp_ge_u32 s60, 1
  s_cbranch_scc1 recurrent_scan__softmax_full_mha__dense_activation_relu__prompt_kernel_sgd29
  s_sleep 8
  s_branch recurrent_scan__softmax_full_mha__dense_activation_relu__prompt_kernel_sg28
recurrent_scan__softmax_full_mha__dense_activation_relu__prompt_kernel_sgd29:
  s_lshl_b32 s58, s57, 2
  s_add_u32 s58, s58, s4
  s_mul_i32 s58, s58, 6144
  s_lshl_b32 s59, s97, 18
  s_add_u32 s58, s58, s59
  v_lshlrev_b32 v4, 7, v1
  s_mov_b32 exec_lo, -1
  s_mov_b32 exec_hi, 0xffff
  buffer_load_dword v163, v4, s[40:43], s58 offen
  s_mov_b64 exec, -1
  s_waitcnt vmcnt(0)
  s_lshl_b32 s58, s57, 2
  s_add_u32 s58, s58, s4
  s_lshl_b32 s58, s58, 12
  v_lshlrev_b32 v4, 7, v1
  s_mov_b64 exec, 0xffffffff
  buffer_load_dword v162, v4, s[32:35], s58 offen
  s_mov_b64 exec, -1
  s_waitcnt vmcnt(0)
  v_mov_b32 v4, 1
  s_mov_b64 exec, 1
  ds_add_u32 v3, v4 offset:4
  s_mov_b64 exec, -1
  v_mov_b32 v4, 1
  s_mov_b64 exec, 1
  ds_add_u32 v3, v4 offset:8
  s_mov_b64 exec, -1
L_ffn_tail:
  s_and_b32 s5, s2, 31
  s_lshr_b32 s6, s2, 5
  s_lshr_b32 s7, s4, 1
  s_and_b32 s8, s4, 1
  v_lshrrev_b32 v4, 3, v1
  v_lshl_add_u32 v9, v4, 10, v8
  s_lshl_b32 s58, s6, 7
  s_lshl_b32 s59, s4, 15
  s_add_u32 s58, s58, s59
  v_add_u32 v9, s58, v9
  v_add_u32 v10, 7168, v9
  v_add_u32 v11, 14336, v9
  v_add_u32 v12, 21504, v9
  s_lshl_b32 s10, s4, 12
  s_add_u32 s10, s10, 65536
  s_mov_b32 s61, 524288
recurrent_scan__softmax_full_mha__dense_activation_relu__prompt_kernel_wd30:
  ds_read_b32 v4, v3 offset:8
  s_waitcnt lgkmcnt(0)
  v_readfirstlane_b32 s60, v4
  s_sub_u32 s61, s61, 1
  s_cbranch_scc1 recurrent_scan__softmax_full_mha__dense_activation_relu__prompt_kernel_wdd31
  s_cmp_ge_u32 s60, 4
  s_cbranch_scc1 recurrent_scan__softmax_full_mha__dense_activation_relu__prompt_kernel_wdd31
  s_sleep 8
  s_branch recurrent_scan__softmax_full_mha__dense_activation_relu__prompt_kernel_wd30
recurrent_scan__softmax_full_mha__dense_activation_relu__prompt_kernel_wdd31:
  s_add_u32 m0, s10, 0
  s_mov_b32 s58, 0
  buffer_load_dwordx4 v9, s[32:35], s58 offen offset:0 lds
  buffer_load_dwordx4 v10, s[32:35], s58 offen offset:1024 lds
  buffer_load_dwordx4 v11, s[32:35], s58 offen offset:2048 lds
  buffer_load_dwordx4 v12, s[32:35], s58 offen offset:3072 lds
  s_waitcnt vmcnt(2)
  s_add_u32 m0, s10, 16384
  s_mov_b32 s58, 131072
  buffer_load_dwordx4 v9, s[32:35], s58 offen offset:0 lds
  buffer_load_dwordx4 v10, s[32:35], s58 offen offset:1024 lds
  buffer_load_dwordx4 v11, s[32:35], s58 offen offset:2048 lds
  buffer_load_dwordx4 v12, s[32:35], s58 offen offset:3072 lds
  s_waitcnt vmcnt(2)
  s_add_u32 m0, s10, 32768
  s_mov_b32 s58, 262144
  buffer_load_dwordx4 v9, s[32:35], s58 offen offset:0 lds
  buffer_load_dwordx4 v10, s[32:35], s58 offen offset:1024 lds
  buffer_load_dwordx4 v11, s[32:35], s58 offen offset:2048 lds
  buffer_load_dwordx4 v12, s[32:35], s58 offen offset:3072 lds
  s_waitcnt vmcnt(2)
  s_add_u32 m0, s10, 49152
  s_mov_b32 s58, 393216
  buffer_load_dwordx4 v9, s[32:35], s58 offen offset:0 lds
  buffer_load_dwordx4 v10, s[32:35], s58 offen offset:1024 lds
  buffer_load_dwordx4 v11, s[32:35], s58 offen offset:2048 lds
  buffer_load_dwordx4 v12, s[32:35], s58 offen offset:3072 lds
  s_waitcnt vmcnt(2)
  s_lshl_b32 s9, s5, 1
  s_add_u32 s9, s9, s7
  s_lshl_b32 s11, s5, 16
  s_lshl_b32 s58, s6, 13
  s_add_u32 s11, s11, s58
  s_lshl_b32 s58, s4, 11
  s_add_u32 s11, s11, s58
  s_add_u32 s11, s11, 10485760
  s_lshl_b32 s12, s5, 10
  s_add_u32 s12, s12, 25198592
  s_lshl_b32 s14, s9, 15
  s_lshl_b32 s58, s8, 12
  s_add_u32 s14, s14, s58
  s_add_u32 s14, s14, 8388608
  v_lshlrev_b32 v15, 7, v1
  s_lshl_b32 s58, s9, 5
  v_and_b32 v4, 31, v1
  v_add_u32 v5, s58, v4
  v_lshlrev_b32 v5, 10, v5
  s_lshl_b32 s58, s6, 7
  s_lshl_b32 s59, s8, 6
  s_add_u32 s58, s58, s59
  v_lshrrev_b32 v7, 5, v1
  v_lshl_add_u32 v6, v7, 4, s58
  v_add_u32 v14, v5, v6
  buffer_load_dwordx4 v[16:19], v14, s[24:27], 0 offen offset:0
  buffer_load_dwordx4 v[20:23], v14, s[24:27], 0 offen offset:32
  s_cmp_eq_u32 s4, 0
  s_cbranch_scc0 L_p2_wait
  s_mov_b64 exec, 0x7f
  s_mov_b32 s61, 524288
recurrent_scan__softmax_full_mha__dense_activation_relu__prompt_kernel_p232:
  buffer_load_dword v4, v15, s[48:51], s12 offen sc1
  s_waitcnt vmcnt(0)
  v_cmp_ne_u32 vcc, s52, v4
  s_sub_u32 s61, s61, 1
  s_cbranch_scc1 recurrent_scan__softmax_full_mha__dense_activation_relu__prompt_kernel_p2d33
  s_cmp_eq_u64 vcc, 0
  s_cbranch_scc1 recurrent_scan__softmax_full_mha__dense_activation_relu__prompt_kernel_p2d33
  s_mov_b64 exec, vcc
  s_sleep 20
  s_branch recurrent_scan__softmax_full_mha__dense_activation_relu__prompt_kernel_p232
recurrent_scan__softmax_full_mha__dense_activation_relu__prompt_kernel_p2d33:
  s_mov_b64 exec, -1
  v_mov_b32 v4, 1
  ds_write_b32 v3, v4 offset:24
  s_branch L_p2_go
L_p2_wait:
  s_mov_b32 s61, 524288
recurrent_scan__softmax_full_mha__dense_activation_relu__prompt_kernel_g234:
  ds_read_b32 v4, v3 offset:24
  s_waitcnt lgkmcnt(0)
  v_readfirstlane_b32 s60, v4
  s_sub_u32 s61, s61, 1
  s_cbranch_scc1 recurrent_scan__softmax_full_mha__dense_activation_relu__prompt_kernel_g2d35
  s_cmp_ge_u32 s60, 1
  s_cbranch_scc1 recurrent_scan__softmax_full_mha__dense_activation_relu__prompt_kernel_g2d35
  s_sleep 16
  s_branch recurrent_scan__softmax_full_mha__dense_activation_relu__prompt_kernel_g234
recurrent_scan__softmax_full_mha__dense_activation_relu__prompt_kernel_g2d35:
L_p2_go:
  buffer_load_dwordx4 v[104:107], v2, s[48:51], s11 offen offset:0 sc1
  buffer_load_dwordx4 v[108:111], v2, s[48:51], s11 offen offset:1024 sc1
  s_add_u32 s11, s11, 2097152
  s_waitcnt vmcnt(4)
  buffer_load_dwordx4 v[112:115], v2, s[48:51], s11 offen offset:0 sc1
  buffer_load_dwordx4 v[116:119], v2, s[48:51], s11 offen offset:1024 sc1
  s_add_u32 s11, s11, 2097152
  s_waitcnt vmcnt(4)
  buffer_load_dwordx4 v[120:123], v2, s[48:51], s11 offen offset:0 sc1
  buffer_load_dwordx4 v[124:127], v2, s[48:51], s11 offen offset:1024 sc1
  s_add_u32 s11, s11, 2097152
  s_waitcnt vmcnt(4)
  buffer_load_dwordx4 v[128:131], v2, s[48:51], s11 offen offset:0 sc1
  buffer_load_dwordx4 v[132:135], v2, s[48:51], s11 offen offset:1024 sc1
  s_add_u32 s11, s11, 2097152
  s_waitcnt vmcnt(4)
  buffer_load_dwordx4 v[136:139], v2, s[48:51], s11 offen offset:0 sc1
  buffer_load_dwordx4 v[140:143], v2, s[48:51], s11 offen offset:1024 sc1
  s_add_u32 s11, s11, 2097152
  s_waitcnt vmcnt(4)
  buffer_load_dwordx4 v[144:147], v2, s[48:51], s11 offen offset:0 sc1
  buffer_load_dwordx4 v[148:151], v2, s[48:51], s11 offen offset:1024 sc1
  s_add_u32 s11, s11, 2097152
  s_waitcnt vmcnt(4)
  buffer_load_dwordx4 v[152:155], v2, s[48:51], s11 offen offset:0 sc1
  buffer_load_dwordx4 v[156:159], v2, s[48:51], s11 offen offset:1024 sc1
  s_waitcnt vmcnt(4)
  s_waitcnt vmcnt(0)
  s_setprio 0
  s_barrier
  v_and_b32 v4, 31, v1
  v_lshrrev_b32 v7, 5, v1
  v_lshlrev_b32 v7, 2, v7
  v_sub_u32 v4, v4, v7
  v_mov_b32 v5, 0x3f80
  v_mov_b32 v6, 0x3f800000
  v_cmp_eq_u32 vcc, 0, v4
  v_cmp_eq_u32 s[16:17], 1, v4
  v_cmp_eq_u32 s[18:19], 2, v4
  v_cmp_eq_u32 s[20:21], 3, v4
  v_cndmask_b32 v40, 0, v5, vcc
  v_cndmask_b32 v41, 0, v5, s[18:19]
  v_cndmask_b32 v40, v40, v6, s[16:17]
  v_cndmask_b32 v41, v41, v6, s[20:21]
  v_cmp_eq_u32 vcc, 8, v4
  v_cmp_eq_u32 s[16:17], 9, v4
  v_cmp_eq_u32 s[18:19], 10, v4
  v_cmp_eq_u32 s[20:21], 11, v4
  v_cndmask_b32 v42, 0, v5, vcc
  v_cndmask_b32 v43, 0, v5, s[18:19]
  v_cndmask_b32 v42, v42, v6, s[16:17]
  v_cndmask_b32 v43, v43, v6, s[20:21]
  v_cmp_eq_u32 vcc, 16, v4
  v_cmp_eq_u32 s[16:17], 17, v4
  v_cmp_eq_u32 s[18:19], 18, v4
  v_cmp_eq_u32 s[20:21], 19, v4
  v_cndmask_b32 v44, 0, v5, vcc
  v_cndmask_b32 v45, 0, v5, s[18:19]
  v_cndmask_b32 v44, v44, v6, s[16:17]
  v_cndmask_b32 v45, v45, v6, s[20:21]
  v_cmp_eq_u32 vcc, 24, v4
  v_cmp_eq_u32 s[16:17], 25, v4
  v_cmp_eq_u32 s[18:19], 26, v4
  v_cmp_eq_u32 s[20:21], 27, v4
  v_cndmask_b32 v46, 0, v5, vcc
  v_cndmask_b32 v47, 0, v5, s[18:19]
  v_cndmask_b32 v46, v46, v6, s[16:17]
  v_cndmask_b32 v47, v47, v6, s[20:21]
  v_mfma_f32_32x32x16_bf16 v[24:39], v[40:43], v[104:107], 0
  s_nop 0
  v_mfma_f32_32x32x16_bf16 v[24:39], v[44:47], v[108:111], v[24:39]
  v_mfma_f32_32x32x16_bf16 v[24:39], v[40:43], v[112:115], v[24:39]
  v_mfma_f32_32x32x16_bf16 v[24:39], v[44:47], v[116:119], v[24:39]
  v_mfma_f32_32x32x16_bf16 v[24:39], v[40:43], v[120:123], v[24:39]
  v_mfma_f32_32x32x16_bf16 v[24:39], v[44:47], v[124:127], v[24:39]
  v_mfma_f32_32x32x16_bf16 v[24:39], v[40:43], v[128:131], v[24:39]
  v_mfma_f32_32x32x16_bf16 v[24:39], v[44:47], v[132:135], v[24:39]
  v_mfma_f32_32x32x16_bf16 v[24:39], v[40:43], v[136:139], v[24:39]
  v_mfma_f32_32x32x16_bf16 v[24:39], v[44:47], v[140:143], v[24:39]
  v_mfma_f32_32x32x16_bf16 v[24:39], v[40:43], v[144:147], v[24:39]
  v_mfma_f32_32x32x16_bf16 v[24:39], v[44:47], v[148:151], v[24:39]
  v_mfma_f32_32x32x16_bf16 v[24:39], v[40:43], v[152:155], v[24:39]
  v_mfma_f32_32x32x16_bf16 v[24:39], v[44:47], v[156:159], v[24:39]
  v_and_b32 v4, 15, v1
  v_lshrrev_b32 v5, 2, v4
  v_lshlrev_b32 v5, 7, v5
  v_lshrrev_b32 v6, 3, v4
  v_xor_b32 v6, s8, v6
  v_lshl_add_u32 v5, v6, 6, v5
  v_and_b32 v6, 3, v4
  v_lshl_add_u32 v5, v6, 3, v5
  v_bfe_u32 v6, v1, 4, 1
  v_lshl_add_u32 v5, v6, 5, v5
  v_lshrrev_b32 v6, 5, v1
  v_lshl_add_u32 v5, v6, 9, v5
  s_lshl_b32 s58, s8, 13
  s_add_u32 s58, s58, 65536
  v_add_u32 v13, s58, v5
  v_xor_b32 v10, 64, v13
  s_lshl_b32 s58, s4, 12
  s_add_u32 s58, s58, 131072
  v_add_u32 v11, s58, v2
  s_lshl_b32 s15, s7, 2
  v_add_u32 v9, s15, v3
  v_mul_f32 v72, 0xbfb8aa3b, v24
  v_mul_f32 v73, 0xbfb8aa3b, v25
  v_mul_f32 v74, 0xbfb8aa3b, v26
  v_mul_f32 v75, 0xbfb8aa3b, v27
  v_mul_f32 v76, 0xbfb8aa3b, v28
  v_mul_f32 v77, 0xbfb8aa3b, v29
  v_mul_f32 v78, 0xbfb8aa3b, v30
  v_mul_f32 v79, 0xbfb8aa3b, v31
  v_mul_f32 v80, 0xbfb8aa3b, v32
  v_mul_f32 v81, 0xbfb8aa3b, v33
  v_mul_f32 v82, 0xbfb8aa3b, v34
  v_mul_f32 v83, 0xbfb8aa3b, v35
  v_mul_f32 v84, 0xbfb8aa3b, v36
  v_mul_f32 v85, 0xbfb8aa3b, v37
  v_mul_f32 v86, 0xbfb8aa3b, v38
  v_mul_f32 v87, 0xbfb8aa3b, v39
  v_exp_f32 v72, v72
  v_exp_f32 v73, v73
  v_exp_f32 v74, v74
  v_exp_f32 v75, v75
  v_exp_f32 v76, v76
  v_exp_f32 v77, v77
  v_exp_f32 v78, v78
  v_exp_f32 v79, v79
  v_exp_f32 v80, v80
  v_exp_f32 v81, v81
  v_exp_f32 v82, v82
  v_exp_f32 v83, v83
  v_exp_f32 v84, v84
  v_exp_f32 v85, v85
  v_exp_f32 v86, v86
  v_exp_f32 v87, v87
  v_add_f32 v72, 1.0, v72
  v_add_f32 v73, 1.0, v73
  v_add_f32 v74, 1.0, v74
  v_add_f32 v75, 1.0, v75
  v_add_f32 v76, 1.0, v76
  v_add_f32 v77, 1.0, v77
  v_add_f32 v78, 1.0, v78
  v_add_f32 v79, 1.0, v79
  v_add_f32 v80, 1.0, v80
  v_add_f32 v81, 1.0, v81
  v_add_f32 v82, 1.0, v82
  v_add_f32 v83, 1.0, v83
  v_add_f32 v84, 1.0, v84
  v_add_f32 v85, 1.0, v85
  v_add_f32 v86, 1.0, v86
  v_add_f32 v87, 1.0, v87
  v_rcp_f32 v72, v72
  v_rcp_f32 v73, v73
  v_rcp_f32 v74, v74
  v_rcp_f32 v75, v75
  v_rcp_f32 v76, v76
  v_rcp_f32 v77, v77
  v_rcp_f32 v78, v78
  v_rcp_f32 v79, v79
  v_rcp_f32 v80, v80
  v_rcp_f32 v81, v81
  v_rcp_f32 v82, v82
  v_rcp_f32 v83, v83
  v_rcp_f32 v84, v84
  v_rcp_f32 v85, v85
  v_rcp_f32 v86, v86
  v_rcp_f32 v87, v87
  v_mul_f32 v24, v24, v72
  v_mul_f32 v25, v25, v73
  v_mul_f32 v26, v26, v74
  v_mul_f32 v27, v27, v75
  v_mul_f32 v28, v28, v76
  v_mul_f32 v29, v29, v77
  v_mul_f32 v30, v30, v78
  v_mul_f32 v31, v31, v79
  v_mul_f32 v32, v32, v80
  v_mul_f32 v33, v33, v81
  v_mul_f32 v34, v34, v82
  v_mul_f32 v35, v35, v83
  v_mul_f32 v36, v36, v84
  v_mul_f32 v37, v37, v85
  v_mul_f32 v38, v38, v86
  v_mul_f32 v39, v39, v87
  v_mov_b32 v40, 0
  v_mov_b32 v41, 0
  v_mov_b32 v42, 0
  v_mov_b32 v43, 0
  v_mov_b32 v44, 0
  v_mov_b32 v45, 0
  v_mov_b32 v46, 0
  v_mov_b32 v47, 0
  v_mov_b32 v48, 0
  v_mov_b32 v49, 0
  v_mov_b32 v50, 0
  v_mov_b32 v51, 0
  v_mov_b32 v52, 0
  v_mov_b32 v53, 0
  v_mov_b32 v54, 0
  v_mov_b32 v55, 0
  v_mov_b32 v56, 0
  v_mov_b32 v57, 0
  v_mov_b32 v58, 0
  v_mov_b32 v59, 0
  v_mov_b32 v60, 0
  v_mov_b32 v61, 0
  v_mov_b32 v62, 0
  v_mov_b32 v63, 0
  v_mov_b32 v64, 0
  v_mov_b32 v65, 0
  v_mov_b32 v66, 0
  v_mov_b32 v67, 0
  v_mov_b32 v68, 0
  v_mov_b32 v69, 0
  v_mov_b32 v70, 0
  v_mov_b32 v71, 0
  s_lshl_b32 s19, s8, 2
  s_mov_b32 s16, 15
  s_mov_b32 s17, 0
  s_mov_b32 s20, 0
  s_mov_b32 s61, 524288
L_o_loop:
  s_cmp_eq_u32 s16, 0
  s_cbranch_scc1 L_o_last
  ds_read_b32 v4, v9 offset:40
  s_waitcnt lgkmcnt(0)
  v_readfirstlane_b32 s18, v4
  s_sub_u32 s61, s61, 1
  s_cselect_b32 s18, -1, s18
  s_lshr_b32 s18, s18, s19
  s_not_b32 s18, s18
  s_bitcmp1_b32 s16, 0
  s_cbranch_scc0 recurrent_scan__softmax_full_mha__dense_activation_relu__prompt_kernel_oi36
  s_and_b32 s58, s18, 15
  s_cbranch_scc1 recurrent_scan__softmax_full_mha__dense_activation_relu__prompt_kernel_oi36
  s_add_u32 s58, s14, 0
  buffer_load_dwordx4 v[104:107], v2, s[48:51], s58 offen offset:0 sc1
  buffer_load_dwordx4 v[108:111], v2, s[48:51], s58 offen offset:1024 sc1
  buffer_load_dwordx4 v[112:115], v2, s[48:51], s58 offen offset:2048 sc1
  buffer_load_dwordx4 v[116:119], v2, s[48:51], s58 offen offset:3072 sc1
  s_bitset0_b32 s16, 0
  s_bitset1_b32 s17, 0
recurrent_scan__softmax_full_mha__dense_activation_relu__prompt_kernel_oi36:
  s_bitcmp1_b32 s16, 1
  s_cbranch_scc0 recurrent_scan__softmax_full_mha__dense_activation_relu__prompt_kernel_oi37
  s_and_b32 s58, s18, 3840
  s_cbranch_scc1 recurrent_scan__softmax_full_mha__dense_activation_relu__prompt_kernel_oi37
  s_add_u32 s58, s14, 8192
  buffer_load_dwordx4 v[120:123], v2, s[48:51], s58 offen offset:0 sc1
  buffer_load_dwordx4 v[124:127], v2, s[48:51], s58 offen offset:1024 sc1
  buffer_load_dwordx4 v[128:131], v2, s[48:51], s58 offen offset:2048 sc1
  buffer_load_dwordx4 v[132:135], v2, s[48:51], s58 offen offset:3072 sc1
  s_bitset0_b32 s16, 1
  s_bitset1_b32 s17, 1
recurrent_scan__softmax_full_mha__dense_activation_relu__prompt_kernel_oi37:
  s_bitcmp1_b32 s16, 2
  s_cbranch_scc0 recurrent_scan__softmax_full_mha__dense_activation_relu__prompt_kernel_oi38
  s_and_b32 s58, s18, 983040
  s_cbranch_scc1 recurrent_scan__softmax_full_mha__dense_activation_relu__prompt_kernel_oi38
  s_add_u32 s58, s14, 16384
  buffer_load_dwordx4 v[136:139], v2, s[48:51], s58 offen offset:0 sc1
  buffer_load_dwordx4 v[140:143], v2, s[48:51], s58 offen offset:1024 sc1
  buffer_load_dwordx4 v[144:147], v2, s[48:51], s58 offen offset:2048 sc1
  buffer_load_dwordx4 v[148:151], v2, s[48:51], s58 offen offset:3072 sc1
  s_bitset0_b32 s16, 2
  s_bitset1_b32 s17, 2
recurrent_scan__softmax_full_mha__dense_activation_relu__prompt_kernel_oi38:
  s_bitcmp1_b32 s16, 3
  s_cbranch_scc0 recurrent_scan__softmax_full_mha__dense_activation_relu__prompt_kernel_oi39
  s_and_b32 s58, s18, 251658240
  s_cbranch_scc1 recurrent_scan__softmax_full_mha__dense_activation_relu__prompt_kernel_oi39
  s_add_u32 s58, s14, 24576
  buffer_load_dwordx4 v[152:155], v2, s[48:51], s58 offen offset:0 sc1
  buffer_load_dwordx4 v[156:159], v2, s[48:51], s58 offen offset:1024 sc1
  buffer_load_dwordx4 v[160:163], v2, s[48:51], s58 offen offset:2048 sc1
  buffer_load_dwordx4 v[164:167], v2, s[48:51], s58 offen offset:3072 sc1
  s_bitset0_b32 s16, 3
  s_bitset1_b32 s17, 3
recurrent_scan__softmax_full_mha__dense_activation_relu__prompt_kernel_oi39:
  s_cmp_eq_u32 s16, 0
  s_cbranch_scc1 L_o_last
  s_getreg_b32 s58, hwreg(HW_REG_IB_STS)
  s_and_b32 s58, s58, 0xc000000f
  s_cbranch_scc1 L_o_loop
  s_branch L_o_mul
L_o_last:
L_o_mul:
  s_cmp_eq_u32 s20, 0
  s_cbranch_scc0 recurrent_scan__softmax_full_mha__dense_activation_relu__prompt_kernel_om40
  s_bitcmp1_b32 s17, 0
  s_cbranch_scc0 L_o_loop
  ds_read_b64_tr_b16 v[72:73], v13 offset:0
  ds_read_b64_tr_b16 v[74:75], v13 offset:1024
  ds_read_b64_tr_b16 v[76:77], v10 offset:0
  ds_read_b64_tr_b16 v[78:79], v10 offset:1024
  ds_read_b64_tr_b16 v[80:81], v13 offset:2048
  ds_read_b64_tr_b16 v[82:83], v13 offset:3072
  ds_read_b64_tr_b16 v[84:85], v10 offset:2048
  ds_read_b64_tr_b16 v[86:87], v10 offset:3072
  ds_read_b64_tr_b16 v[88:89], v13 offset:4096
  ds_read_b64_tr_b16 v[90:91], v13 offset:5120
  ds_read_b64_tr_b16 v[92:93], v10 offset:4096
  ds_read_b64_tr_b16 v[94:95], v10 offset:5120
  ds_read_b64_tr_b16 v[96:97], v13 offset:6144
  ds_read_b64_tr_b16 v[98:99], v13 offset:7168
  ds_read_b64_tr_b16 v[100:101], v10 offset:6144
  ds_read_b64_tr_b16 v[102:103], v10 offset:7168
  s_waitcnt vmcnt(0)
  s_waitcnt lgkmcnt(12)
  v_mfma_f32_32x32x16_bf16 v[40:55], v[72:75], v[104:107], v[40:55]
  v_mfma_f32_32x32x16_bf16 v[56:71], v[76:79], v[104:107], v[56:71]
  s_waitcnt lgkmcnt(8)
  v_mfma_f32_32x32x16_bf16 v[40:55], v[80:83], v[108:111], v[40:55]
  v_mfma_f32_32x32x16_bf16 v[56:71], v[84:87], v[108:111], v[56:71]
  s_waitcnt lgkmcnt(4)
  v_mfma_f32_32x32x16_bf16 v[40:55], v[88:91], v[112:115], v[40:55]
  v_mfma_f32_32x32x16_bf16 v[56:71], v[92:95], v[112:115], v[56:71]
  s_waitcnt lgkmcnt(0)
  v_mfma_f32_32x32x16_bf16 v[40:55], v[96:99], v[116:119], v[40:55]
  v_mfma_f32_32x32x16_bf16 v[56:71], v[100:103], v[116:119], v[56:71]
  s_mov_b32 s20, 1
  s_branch L_o_loop
recurrent_scan__softmax_full_mha__dense_activation_relu__prompt_kernel_om40:
  s_cmp_eq_u32 s20, 1
  s_cbranch_scc0 recurrent_scan__softmax_full_mha__dense_activation_relu__prompt_kernel_om41
  s_bitcmp1_b32 s17, 2
  s_cbranch_scc0 L_o_loop
  ds_read_b64_tr_b16 v[72:73], v13 offset:32768
  ds_read_b64_tr_b16 v[74:75], v13 offset:33792
  ds_read_b64_tr_b16 v[76:77], v10 offset:32768
  ds_read_b64_tr_b16 v[78:79], v10 offset:33792
  ds_read_b64_tr_b16 v[80:81], v13 offset:34816
  ds_read_b64_tr_b16 v[82:83], v13 offset:35840
  ds_read_b64_tr_b16 v[84:85], v10 offset:34816
  ds_read_b64_tr_b16 v[86:87], v10 offset:35840
  ds_read_b64_tr_b16 v[88:89], v13 offset:36864
  ds_read_b64_tr_b16 v[90:91], v13 offset:37888
  ds_read_b64_tr_b16 v[92:93], v10 offset:36864
  ds_read_b64_tr_b16 v[94:95], v10 offset:37888
  ds_read_b64_tr_b16 v[96:97], v13 offset:38912
  ds_read_b64_tr_b16 v[98:99], v13 offset:39936
  ds_read_b64_tr_b16 v[100:101], v10 offset:38912
  ds_read_b64_tr_b16 v[102:103], v10 offset:39936
  s_waitcnt vmcnt(0)
  s_waitcnt lgkmcnt(12)
  v_mfma_f32_32x32x16_bf16 v[40:55], v[72:75], v[136:139], v[40:55]
  v_mfma_f32_32x32x16_bf16 v[56:71], v[76:79], v[136:139], v[56:71]
  s_waitcnt lgkmcnt(8)
  v_mfma_f32_32x32x16_bf16 v[40:55], v[80:83], v[140:143], v[40:55]
  v_mfma_f32_32x32x16_bf16 v[56:71], v[84:87], v[140:143], v[56:71]
  s_waitcnt lgkmcnt(4)
  v_mfma_f32_32x32x16_bf16 v[40:55], v[88:91], v[144:147], v[40:55]
  v_mfma_f32_32x32x16_bf16 v[56:71], v[92:95], v[144:147], v[56:71]
  s_waitcnt lgkmcnt(0)
  v_mfma_f32_32x32x16_bf16 v[40:55], v[96:99], v[148:151], v[40:55]
  v_mfma_f32_32x32x16_bf16 v[56:71], v[100:103], v[148:151], v[56:71]
  s_mov_b32 s20, 2
  s_branch L_o_loop
recurrent_scan__softmax_full_mha__dense_activation_relu__prompt_kernel_om41:
  s_cmp_eq_u32 s20, 2
  s_cbranch_scc0 recurrent_scan__softmax_full_mha__dense_activation_relu__prompt_kernel_om42
  s_bitcmp1_b32 s17, 3
  s_cbranch_scc0 L_o_loop
  ds_read_b64_tr_b16 v[72:73], v13 offset:49152
  ds_read_b64_tr_b16 v[74:75], v13 offset:50176
  ds_read_b64_tr_b16 v[76:77], v10 offset:49152
  ds_read_b64_tr_b16 v[78:79], v10 offset:50176
  ds_read_b64_tr_b16 v[80:81], v13 offset:51200
  ds_read_b64_tr_b16 v[82:83], v13 offset:52224
  ds_read_b64_tr_b16 v[84:85], v10 offset:51200
  ds_read_b64_tr_b16 v[86:87], v10 offset:52224
  ds_read_b64_tr_b16 v[88:89], v13 offset:53248
  ds_read_b64_tr_b16 v[90:91], v13 offset:54272
  ds_read_b64_tr_b16 v[92:93], v10 offset:53248
  ds_read_b64_tr_b16 v[94:95], v10 offset:54272
  ds_read_b64_tr_b16 v[96:97], v13 offset:55296
  ds_read_b64_tr_b16 v[98:99], v13 offset:56320
  ds_read_b64_tr_b16 v[100:101], v10 offset:55296
  ds_read_b64_tr_b16 v[102:103], v10 offset:56320
  s_waitcnt vmcnt(0)
  s_waitcnt lgkmcnt(12)
  v_mfma_f32_32x32x16_bf16 v[40:55], v[72:75], v[152:155], v[40:55]
  v_mfma_f32_32x32x16_bf16 v[56:71], v[76:79], v[152:155], v[56:71]
  s_waitcnt lgkmcnt(8)
  v_mfma_f32_32x32x16_bf16 v[40:55], v[80:83], v[156:159], v[40:55]
  v_mfma_f32_32x32x16_bf16 v[56:71], v[84:87], v[156:159], v[56:71]
  s_waitcnt lgkmcnt(4)
  v_mfma_f32_32x32x16_bf16 v[40:55], v[88:91], v[160:163], v[40:55]
  v_mfma_f32_32x32x16_bf16 v[56:71], v[92:95], v[160:163], v[56:71]
  s_waitcnt lgkmcnt(0)
  v_mfma_f32_32x32x16_bf16 v[40:55], v[96:99], v[164:167], v[40:55]
  v_mfma_f32_32x32x16_bf16 v[56:71], v[100:103], v[164:167], v[56:71]
  s_mov_b32 s20, 3
  s_branch L_o_loop
recurrent_scan__softmax_full_mha__dense_activation_relu__prompt_kernel_om42:
  s_cmp_eq_u32 s20, 3
  s_cbranch_scc0 recurrent_scan__softmax_full_mha__dense_activation_relu__prompt_kernel_om43
  s_bitcmp1_b32 s17, 1
  s_cbranch_scc0 L_o_loop
  ds_read_b64_tr_b16 v[72:73], v13 offset:16384
  ds_read_b64_tr_b16 v[74:75], v13 offset:17408
  ds_read_b64_tr_b16 v[76:77], v10 offset:16384
  ds_read_b64_tr_b16 v[78:79], v10 offset:17408
  ds_read_b64_tr_b16 v[80:81], v13 offset:18432
  ds_read_b64_tr_b16 v[82:83], v13 offset:19456
  ds_read_b64_tr_b16 v[84:85], v10 offset:18432
  ds_read_b64_tr_b16 v[86:87], v10 offset:19456
  ds_read_b64_tr_b16 v[88:89], v13 offset:20480
  ds_read_b64_tr_b16 v[90:91], v13 offset:21504
  ds_read_b64_tr_b16 v[92:93], v10 offset:20480
  ds_read_b64_tr_b16 v[94:95], v10 offset:21504
  ds_read_b64_tr_b16 v[96:97], v13 offset:22528
  ds_read_b64_tr_b16 v[98:99], v13 offset:23552
  ds_read_b64_tr_b16 v[100:101], v10 offset:22528
  ds_read_b64_tr_b16 v[102:103], v10 offset:23552
  s_waitcnt vmcnt(0)
  s_waitcnt lgkmcnt(12)
  v_mfma_f32_32x32x16_bf16 v[40:55], v[72:75], v[120:123], v[40:55]
  v_mfma_f32_32x32x16_bf16 v[56:71], v[76:79], v[120:123], v[56:71]
  s_waitcnt lgkmcnt(8)
  v_mfma_f32_32x32x16_bf16 v[40:55], v[80:83], v[124:127], v[40:55]
  v_mfma_f32_32x32x16_bf16 v[56:71], v[84:87], v[124:127], v[56:71]
  s_waitcnt lgkmcnt(4)
  v_mfma_f32_32x32x16_bf16 v[40:55], v[88:91], v[128:131], v[40:55]
  v_mfma_f32_32x32x16_bf16 v[56:71], v[92:95], v[128:131], v[56:71]
  s_waitcnt lgkmcnt(0)
  v_mfma_f32_32x32x16_bf16 v[40:55], v[96:99], v[132:135], v[40:55]
  v_mfma_f32_32x32x16_bf16 v[56:71], v[100:103], v[132:135], v[56:71]
recurrent_scan__softmax_full_mha__dense_activation_relu__prompt_kernel_om43:
  v_permlane32_swap_b32 v16, v18
  v_permlane32_swap_b32 v17, v19
  v_permlane32_swap_b32 v20, v22
  v_permlane32_swap_b32 v21, v23
  v_lshlrev_b32 v72, 16, v16
  v_and_b32 v73, 0xffff0000, v16
  v_lshlrev_b32 v74, 16, v17
  v_and_b32 v75, 0xffff0000, v17
  v_lshlrev_b32 v76, 16, v18
  v_and_b32 v77, 0xffff0000, v18
  v_lshlrev_b32 v78, 16, v19
  v_and_b32 v79, 0xffff0000, v19
  v_lshlrev_b32 v80, 16, v20
  v_and_b32 v81, 0xffff0000, v20
  v_lshlrev_b32 v82, 16, v21
  v_and_b32 v83, 0xffff0000, v21
  v_lshlrev_b32 v84, 16, v22
  v_and_b32 v85, 0xffff0000, v22
  v_lshlrev_b32 v86, 16, v23
  v_and_b32 v87, 0xffff0000, v23
  ds_write_b128 v11, v[56:59] offset:0
  ds_write_b128 v11, v[60:63] offset:1024
  ds_write_b128 v11, v[64:67] offset:2048
  ds_write_b128 v11, v[68:71] offset:3072
  v_xor_b32 v11, 4096, v11
  s_waitcnt lgkmcnt(0)
  s_barrier
  ds_read_b128 v[104:107], v11 offset:0
  ds_read_b128 v[108:111], v11 offset:1024
  ds_read_b128 v[112:115], v11 offset:2048
  ds_read_b128 v[116:119], v11 offset:3072
  s_waitcnt lgkmcnt(3)
  v_add_f32 v40, v40, v104
  v_add_f32 v41, v41, v105
  v_add_f32 v42, v42, v106
  v_add_f32 v43, v43, v107
  v_fma_f32 v72, v40, v24, v72
  v_fma_f32 v73, v41, v25, v73
  v_fma_f32 v74, v42, v26, v74
  v_fma_f32 v75, v43, v27, v75
  v_cvt_pk_bf16_f32 v16, v72, v73
  v_cvt_pk_bf16_f32 v17, v74, v75
  s_waitcnt lgkmcnt(2)
  v_add_f32 v44, v44, v108
  v_add_f32 v45, v45, v109
  v_add_f32 v46, v46, v110
  v_add_f32 v47, v47, v111
  v_fma_f32 v76, v44, v28, v76
  v_fma_f32 v77, v45, v29, v77
  v_fma_f32 v78, v46, v30, v78
  v_fma_f32 v79, v47, v31, v79
  v_cvt_pk_bf16_f32 v18, v76, v77
  v_cvt_pk_bf16_f32 v19, v78, v79
  s_nop 0
  v_permlane32_swap_b32 v16, v18
  v_permlane32_swap_b32 v17, v19
  buffer_store_dwordx4 v[16:19], v14, s[44:47], 0 offen offset:0
  s_waitcnt lgkmcnt(1)
  v_add_f32 v48, v48, v112
  v_add_f32 v49, v49, v113
  v_add_f32 v50, v50, v114
  v_add_f32 v51, v51, v115
  v_fma_f32 v80, v48, v32, v80
  v_fma_f32 v81, v49, v33, v81
  v_fma_f32 v82, v50, v34, v82
  v_fma_f32 v83, v51, v35, v83
  v_cvt_pk_bf16_f32 v20, v80, v81
  v_cvt_pk_bf16_f32 v21, v82, v83
  s_waitcnt lgkmcnt(0)
  v_add_f32 v52, v52, v116
  v_add_f32 v53, v53, v117
  v_add_f32 v54, v54, v118
  v_add_f32 v55, v55, v119
  v_fma_f32 v84, v52, v36, v84
  v_fma_f32 v85, v53, v37, v85
  v_fma_f32 v86, v54, v38, v86
  v_fma_f32 v87, v55, v39, v87
  v_cvt_pk_bf16_f32 v22, v84, v85
  v_cvt_pk_bf16_f32 v23, v86, v87
  s_nop 0
  v_permlane32_swap_b32 v20, v22
  v_permlane32_swap_b32 v21, v23
  buffer_store_dwordx4 v[20:23], v14, s[44:47], 0 offen offset:32
  s_or_b32 s58, s2, s4
  s_cbranch_scc1 L_notok
  s_mov_b32 s58, 25231360
  v_mov_b32 v5, s52
  v_mov_b32 v4, 0
  s_mov_b64 exec, 1
  buffer_store_dword v5, v4, s[48:51], s58 offen sc1
  s_mov_b64 exec, -1
L_notok:
L_done:
  s_endpgm
L_end:
  .fill (33024-(L_end-recurrent_scan__softmax_full_mha__dense_activation_relu__prompt_kernel))/4, 4, 0xbf810000
.section .rodata,"a"
.p2align 6
.amdhsa_kernel recurrent_scan__softmax_full_mha__dense_activation_relu__prompt_kernel
  .amdhsa_next_free_vgpr 168
  .amdhsa_next_free_sgpr 102
  .amdhsa_accum_offset 168
  .amdhsa_group_segment_fixed_size 0
  .amdhsa_kernarg_size 72
  .amdhsa_user_sgpr_count 2
  .amdhsa_user_sgpr_kernarg_segment_ptr 1
  .amdhsa_system_sgpr_workgroup_id_x 1
  .amdhsa_float_denorm_mode_32 3
.end_amdhsa_kernel
```
